```python
import torch

def _softmax(x, axis=-1):
    return torch.softmax(x, dim=axis)
def _gelu(x):
    return torch.nn.functional.gelu(x, approximate="tanh")
def _silu(x):
    return torch.nn.functional.silu(x)
def _sigmoid(x):
    return torch.sigmoid(x)
def _layernorm(x, axis=-1, eps=1e-5):
    m = x.mean(dim=axis, keepdim=True)
    v = x.var(dim=axis, keepdim=True, unbiased=False)
    return (x - m) / torch.sqrt(v + eps)
def _scatter_add(tgt, idx, src, axis=0):
    return tgt.clone().index_add_(axis, idx, src)
def _segment_sum(src, seg, n):
    out = torch.zeros((n,) + src.shape[1:], dtype=src.dtype)
    return out.index_add_(0, seg, src)
def _pad(x, pw):
    flat = tuple(v for pair in reversed(pw) for v in pair)
    return torch.nn.functional.pad(x, flat)

kernel_name = 'parallel_sum__grouped_kv_mqa__dense_activation_relu__prompt'

def setup_inputs():

    _w = (lambda a: (lambda t: t.to(torch.bfloat16) if t.is_floating_point() else t)(torch.as_tensor(a)))
    def _A_setup():
        B, S, D, H = 1, 2048, 512, 32
        Dh = D // H
        return {
            "x": _w((lambda *s: torch.randn(*s, dtype=torch.bfloat16) * 0.05)(B, S, D)),
            "wq": _w((lambda *s: torch.randn(*s, dtype=torch.bfloat16) * 0.2)(D, H * Dh)),
            "wk": _w((lambda *s: torch.randn(*s, dtype=torch.bfloat16) * 0.2)(D, Dh)),
            "wv": _w((lambda *s: torch.randn(*s, dtype=torch.bfloat16) * 0.1)(D, Dh)),
            "wo": _w((lambda *s: torch.randn(*s, dtype=torch.bfloat16) * 0.1)(H * Dh, D)),
        }
    _A_in = _A_setup()

    def _B_setup():
        B, S, D, Dff = 1, 2048, 512, 1792
        return {
            "x": _w((lambda *s: torch.randn(*s, dtype=torch.bfloat16) * 0.05)(B, S, D)),
            "w1": _w((lambda *s: torch.randn(*s, dtype=torch.bfloat16) * 0.1)(D, Dff)),
            "w2": _w((lambda *s: torch.randn(*s, dtype=torch.bfloat16) * 0.1)(Dff, D)),
        }
    _B_in = _B_setup()

    return {
        "A_x": _A_in["x"],
        "A_wq": _A_in["wq"],
        "A_wk": _A_in["wk"],
        "A_wv": _A_in["wv"],
        "A_wo": _A_in["wo"],
        "B_x": _B_in["x"],
        "B_w1": _B_in["w1"],
        "B_w2": _B_in["w2"],
    }

def reference(A_x, A_wq, A_wk, A_wv, A_wo, B_x, B_w1, B_w2):
    def _A_ref(x, wq, wk, wv, wo):
        B, S, D = x.shape
        H = 32
        Dh = D // H
        q = (lambda x, *d: x.permute(*d))((x @ wq).reshape(B, S, H, Dh), 0, 2, 1, 3)
        k = x @ wk
        v = x @ wv
        scores = torch.einsum("bhqd,bkd->bhqk", q, k) * (Dh ** -0.5)
        p = _softmax(scores, axis=-1)
        o = torch.einsum("bhqk,bkd->bhqd", p, v)
        return (lambda x, *d: x.permute(*d))(o, 0, 2, 1, 3).reshape(B, S, H * Dh) @ wo

    def _B_ref(x, w1, w2):
        h = torch.einsum("bsd,df->bsf", x, w1)
        zero = torch.zeros_like(h)
        h = torch.maximum(h, zero)
        return torch.einsum("bsf,fd->bsd", h, w2)

    x = A_x
    xn = _layernorm(x, axis=-1)
    return x + _A_ref(xn, A_wq, A_wk, A_wv, A_wo) + _B_ref(xn, B_w1, B_w2)
```

```asm
; @launch grid=(256,1,1) block=(512,1,1) lds=163840
.amdgcn_target "amdgcn-amd-amdhsa--gfx950"
.text
.globl parallel_sum__grouped_kv_mqa__dense_activation_relu__prompt_kernel
.p2align 8
.type parallel_sum__grouped_kv_mqa__dense_activation_relu__prompt_kernel,@function
parallel_sum__grouped_kv_mqa__dense_activation_relu__prompt_kernel:
    s_cmp_ge_u32 s2, 256
    s_cbranch_scc1 L_END
    s_load_dwordx2 s[4:5], s[0:1], 0
    s_load_dwordx2 s[24:25], s[0:1], 8
    s_load_dwordx4 s[60:63], s[0:1], 16
    s_load_dwordx2 s[16:17], s[0:1], 32
    s_load_dwordx2 s[32:33], s[0:1], 48
    s_load_dwordx2 s[20:21], s[0:1], 56
    s_load_dwordx2 s[8:9], s[0:1], 64
    s_load_dwordx2 s[36:37], s[0:1], 72
    s_load_dwordx2 s[12:13], s[0:1], 80
    s_memrealtime s[98:99]
    v_lshrrev_b32 v4, 6, v0
    v_and_b32 v1, 63, v0
    s_lshr_b32 s96, s2, 3
    v_readfirstlane_b32 s40, v4
    s_lshr_b32 s97, s96, 3
    s_and_b32 s43, s2, 1
    s_lshl_b32 s43, s43, 2
    s_add_u32 s42, s43, s97
    s_and_b32 s43, s2, 6
    s_lshl_b32 s43, s43, 2
    s_and_b32 s41, s96, 7
    s_add_u32 s41, s41, s43
    s_mov_b32 s6, 2097152
    s_mov_b32 s7, 0x20000
    v_lshrrev_b32 v4, 3, v1
    v_and_b32 v5, 7, v1
    v_lshlrev_b32 v6, 10, v4
    v_lshl_or_b32 v6, v5, 4, v6
    s_and_b32 s45, s97, 1
    s_lshl_b32 s45, s45, 2
    s_xor_b32 s49, s40, s45
    s_lshl_b32 s43, s41, 16
    s_lshl_b32 s44, s49, 13
    s_add_u32 s44, s43, s44
    s_mov_b32 s38, 256
    s_mov_b32 s39, 0x20000
    v_mov_b32 v15, 0
    v_lshlrev_b32 v8, 4, v1
    s_sub_u32 s56, s40, 4
    s_mov_b32 s30, 16384
    s_mov_b32 s31, 0x20000
    v_lshlrev_b32 v28, 7, v1
    v_mov_b32 v2, 159744
    v_mov_b32 v3, 1
    v_lshl_add_u32 v29, v1, 2, v2
    ds_write_b32 v29, v15
    s_cmp_lt_u32 s42, 4
    s_waitcnt lgkmcnt(0)
    s_barrier
    s_cselect_b32 s28, s60, s62
    s_cselect_b32 s29, s61, s63
    s_cmp_lg_u32 s97, 1
    s_cbranch_scc1 L_PFE
    s_cmp_lg_u32 s40, 0
    s_cbranch_scc1 L_PFE
    s_and_b32 s45, s96, 7
    s_lshl_b32 s45, s45, 11
    s_mov_b64 exec, 0xffff
    buffer_load_dword v210, v28, s[28:31], s45 offen
    s_mov_b64 exec, -1
L_PFE:
    s_or_b32 s43, s2, s40
    s_cmp_lg_u32 s43, 0
    s_cbranch_scc1 L_NN
    s_or_b32 s43, s98, 1
    v_mov_b32 v14, s43
    s_mov_b64 exec, 1
    buffer_store_dword v14, v15, s[36:39], 0 offen sc1
    s_mov_b64 exec, -1
L_NN:
    buffer_load_dwordx4 v[32:35], v6, s[4:7], s44 offen offset:0
    buffer_load_dwordx4 v[36:39], v6, s[4:7], s44 offen offset:128
    buffer_load_dwordx4 v[40:43], v6, s[4:7], s44 offen offset:256
    buffer_load_dwordx4 v[44:47], v6, s[4:7], s44 offen offset:384
    buffer_load_dwordx4 v[48:51], v6, s[4:7], s44 offen offset:512
    buffer_load_dwordx4 v[52:55], v6, s[4:7], s44 offen offset:640
    buffer_load_dwordx4 v[56:59], v6, s[4:7], s44 offen offset:768
    buffer_load_dwordx4 v[60:63], v6, s[4:7], s44 offen offset:896
    s_cmp_lt_u32 s40, 4
    s_cbranch_scc1 L_NKV
    s_cmp_lg_u32 s97, 0
    s_cbranch_scc1 L_NKV
    s_mul_i32 s44, s56, 4224
    s_add_u32 m0, s44, 135168
    s_lshl_b32 s43, s56, 12
    buffer_load_dwordx4 v8, s[28:31], s43 offen offset:0 lds
    buffer_load_dwordx4 v8, s[28:31], s43 offen offset:1024 lds
    buffer_load_dwordx4 v8, s[28:31], s43 offen offset:2048 lds
    buffer_load_dwordx4 v8, s[28:31], s43 offen offset:3072 lds
L_NKV:
    s_mov_b32 s26, 524288
    s_mov_b32 s27, 0x20000
    s_mov_b32 s18, 524288
    s_mov_b32 s19, 0x20000
    s_mov_b32 s34, 1835008
    s_mov_b32 s35, 0x20000
    s_mov_b32 s22, 1835008
    s_mov_b32 s23, 0x20000
    s_mov_b32 s10, 2097152
    s_mov_b32 s11, 0x20000
    s_mov_b32 s14, 16777216
    s_mov_b32 s15, 0x20000
    v_lshrrev_b32 v24, 5, v1
    v_bfe_u32 v23, v1, 2, 2
    v_lshl_add_u32 v20, v24, 2, v23
    v_bfe_u32 v25, v1, 4, 1
    v_and_b32 v26, 3, v1
    v_lshlrev_b32 v22, 4, v26
    v_lshl_add_u32 v21, v25, 6, v22
    s_mul_i32 s44, s49, 8320
    s_add_u32 s44, s44, 67584
    v_mul_u32_u24 v7, 1040, v4
    v_lshl_add_u32 v7, v5, 4, v7
    v_add_u32 v7, s44, v7
    s_mul_i32 s51, s41, 294912
    s_add_u32 s51, s51, 524288
    s_lshl_b32 s52, s41, 16
    s_add_u32 s52, s52, 12582912
    v_lshrrev_b32 v13, 3, v0
    v_lshlrev_b32 v13, 10, v13
    v_lshl_or_b32 v13, v5, 4, v13
    s_lshl_b32 s44, s41, 16
    s_lshl_b32 s45, s42, 7
    s_add_u32 s44, s44, s45
    v_add_u32 v13, s44, v13
    v_lshlrev_b32 v23, 6, v23
    v_lshl_add_u32 v23, v25, 5, v23
    v_lshl_add_u32 v23, v26, 3, v23
    v_mov_b32 v138, 0
    v_mov_b32 v139, 0
    v_lshrrev_b32 v27, 4, v1
    v_and_b32 v28, 15, v1
    v_min_u32 v28, 13, v28
    v_lshlrev_b32 v28, 7, v28
    s_mov_b32 s44, 3584
    v_mad_u32_u24 v27, v27, s44, v28
    s_sub_u32 s43, s96, 8
    s_lshl_b32 s43, s43, 2
    s_and_b32 s45, s40, 3
    s_add_u32 s43, s43, s45
    s_mul_i32 s43, s43, 14336
    s_lshr_b32 s44, s42, 2
    s_mul_i32 s44, s44, 1792
    s_add_u32 s43, s43, s44
    v_add_u32 v27, s43, v27
    s_cmp_ge_u32 s40, 4
    s_cbranch_scc1 L_G_ADDR
    v_lshl_add_u32 v9, v20, 10, v21
    v_add_u32 v10, 7168, v9
    s_lshl_b32 s48, s40, 16
    s_lshl_b32 s43, s42, 7
    s_add_u32 s48, s48, s43
    s_branch L_LN
L_G_ADDR:
    s_lshr_b32 s44, s42, 2
    s_mul_i32 s57, s44, 28
    s_lshl_b32 s43, s97, 2
    s_add_u32 s43, s43, s56
    s_lshl_b32 s43, s43, 1
    s_sub_u32 s43, s43, 4
    s_cmp_eq_u32 s97, 0
    s_cselect_b32 s43, s56, s43
    s_add_u32 s57, s57, s43
    s_lshl_b32 s48, s57, 6
    s_mov_b32 s44, 3584
    v_mad_u32_u24 v9, v20, s44, v21
    v_add_u32 v10, 27648, v9
    s_mov_b32 s49, 57344
    s_mul_i32 s46, s56, 6144
    s_add_u32 s46, s46, 135168
    s_cmp_lg_u32 s97, 0
    s_cbranch_scc1 L_G_EARLY
    v_lshrrev_b32 v28, 2, v1
    v_mad_u32_u24 v9, v28, s44, v22
    v_add_u32 v10, 56320, v9
    s_mov_b32 s49, 114688
    v_and_b32 v142, 15, v1
    v_lshrrev_b32 v143, 4, v1
    s_mul_i32 s43, s56, 16640
    s_add_u32 s43, s43, 67584
    v_mul_u32_u24 v136, 1040, v142
    v_lshl_add_u32 v136, v143, 8, v136
    v_add_u32 v136, s43, v136
    v_mul_u32_u24 v137, 4224, v143
    v_lshl_add_u32 v137, v142, 3, v137
    v_add_u32 v137, 135168, v137
    v_and_b32 v140, 1, v143
    v_lshrrev_b32 v141, 1, v143
    v_lshlrev_b32 v142, 4, v142
    v_lshl_add_u32 v138, v140, 9, v142
    v_lshl_add_u32 v138, v141, 3, v138
    v_lshl_add_u32 v139, v141, 8, v142
    v_lshl_add_u32 v139, v140, 3, v139
    s_lshl_b32 s43, s41, 1
    s_lshr_b32 s44, s56, 1
    s_add_u32 s43, s43, s44
    s_mul_i32 s3, s43, 2112
    s_and_b32 s44, s56, 1
    s_lshl_b32 s43, s44, 8
    s_mul_i32 s44, s44, 544
    s_add_u32 s44, s44, 1024
    s_cmp_eq_u32 s42, 0
    s_cselect_b32 s43, s43, s44
    s_cselect_b64 vcc, -1, 0
    s_add_u32 s3, s3, s43
    v_cndmask_b32 v138, v139, v138, vcc
    v_lshlrev_b32 v139, 3, v1
    v_mov_b32 v140, 0x3f803f80
    v_cmp_gt_u32 vcc, 2, v1
    s_nop 1
    v_cndmask_b32 v140, 0, v140, vcc
    v_mov_b32 v141, v140
L_LN:
    s_waitcnt vmcnt(7)
    v_lshlrev_b32 v64, 16, v32
    v_and_b32 v65, 0xffff0000, v32
    v_lshlrev_b32 v66, 16, v33
    v_and_b32 v67, 0xffff0000, v33
    v_lshlrev_b32 v68, 16, v34
    v_and_b32 v69, 0xffff0000, v34
    v_lshlrev_b32 v70, 16, v35
    v_and_b32 v71, 0xffff0000, v35
    v_pk_mul_f32 v[132:133], v[64:65], v[64:65]
    v_mov_b64 v[128:129], v[64:65]
    v_pk_mul_f32 v[134:135], v[66:67], v[66:67]
    v_mov_b64 v[130:131], v[66:67]
    v_pk_add_f32 v[128:129], v[128:129], v[68:69]
    v_pk_fma_f32 v[132:133], v[68:69], v[68:69], v[132:133]
    v_pk_add_f32 v[130:131], v[130:131], v[70:71]
    v_pk_fma_f32 v[134:135], v[70:71], v[70:71], v[134:135]
    s_waitcnt vmcnt(6)
    v_lshlrev_b32 v72, 16, v36
    v_and_b32 v73, 0xffff0000, v36
    v_lshlrev_b32 v74, 16, v37
    v_and_b32 v75, 0xffff0000, v37
    v_lshlrev_b32 v76, 16, v38
    v_and_b32 v77, 0xffff0000, v38
    v_lshlrev_b32 v78, 16, v39
    v_and_b32 v79, 0xffff0000, v39
    v_pk_add_f32 v[128:129], v[128:129], v[72:73]
    v_pk_fma_f32 v[132:133], v[72:73], v[72:73], v[132:133]
    v_pk_add_f32 v[130:131], v[130:131], v[74:75]
    v_pk_fma_f32 v[134:135], v[74:75], v[74:75], v[134:135]
    v_pk_add_f32 v[128:129], v[128:129], v[76:77]
    v_pk_fma_f32 v[132:133], v[76:77], v[76:77], v[132:133]
    v_pk_add_f32 v[130:131], v[130:131], v[78:79]
    v_pk_fma_f32 v[134:135], v[78:79], v[78:79], v[134:135]
    s_waitcnt vmcnt(5)
    v_lshlrev_b32 v80, 16, v40
    v_and_b32 v81, 0xffff0000, v40
    v_lshlrev_b32 v82, 16, v41
    v_and_b32 v83, 0xffff0000, v41
    v_lshlrev_b32 v84, 16, v42
    v_and_b32 v85, 0xffff0000, v42
    v_lshlrev_b32 v86, 16, v43
    v_and_b32 v87, 0xffff0000, v43
    v_pk_add_f32 v[128:129], v[128:129], v[80:81]
    v_pk_fma_f32 v[132:133], v[80:81], v[80:81], v[132:133]
    v_pk_add_f32 v[130:131], v[130:131], v[82:83]
    v_pk_fma_f32 v[134:135], v[82:83], v[82:83], v[134:135]
    v_pk_add_f32 v[128:129], v[128:129], v[84:85]
    v_pk_fma_f32 v[132:133], v[84:85], v[84:85], v[132:133]
    v_pk_add_f32 v[130:131], v[130:131], v[86:87]
    v_pk_fma_f32 v[134:135], v[86:87], v[86:87], v[134:135]
    s_waitcnt vmcnt(4)
    v_lshlrev_b32 v88, 16, v44
    v_and_b32 v89, 0xffff0000, v44
    v_lshlrev_b32 v90, 16, v45
    v_and_b32 v91, 0xffff0000, v45
    v_lshlrev_b32 v92, 16, v46
    v_and_b32 v93, 0xffff0000, v46
    v_lshlrev_b32 v94, 16, v47
    v_and_b32 v95, 0xffff0000, v47
    v_pk_add_f32 v[128:129], v[128:129], v[88:89]
    v_pk_fma_f32 v[132:133], v[88:89], v[88:89], v[132:133]
    v_pk_add_f32 v[130:131], v[130:131], v[90:91]
    v_pk_fma_f32 v[134:135], v[90:91], v[90:91], v[134:135]
    v_pk_add_f32 v[128:129], v[128:129], v[92:93]
    v_pk_fma_f32 v[132:133], v[92:93], v[92:93], v[132:133]
    v_pk_add_f32 v[130:131], v[130:131], v[94:95]
    v_pk_fma_f32 v[134:135], v[94:95], v[94:95], v[134:135]
    s_waitcnt vmcnt(3)
    v_lshlrev_b32 v96, 16, v48
    v_and_b32 v97, 0xffff0000, v48
    v_lshlrev_b32 v98, 16, v49
    v_and_b32 v99, 0xffff0000, v49
    v_lshlrev_b32 v100, 16, v50
    v_and_b32 v101, 0xffff0000, v50
    v_lshlrev_b32 v102, 16, v51
    v_and_b32 v103, 0xffff0000, v51
    v_pk_add_f32 v[128:129], v[128:129], v[96:97]
    v_pk_fma_f32 v[132:133], v[96:97], v[96:97], v[132:133]
    v_pk_add_f32 v[130:131], v[130:131], v[98:99]
    v_pk_fma_f32 v[134:135], v[98:99], v[98:99], v[134:135]
    v_pk_add_f32 v[128:129], v[128:129], v[100:101]
    v_pk_fma_f32 v[132:133], v[100:101], v[100:101], v[132:133]
    v_pk_add_f32 v[130:131], v[130:131], v[102:103]
    v_pk_fma_f32 v[134:135], v[102:103], v[102:103], v[134:135]
    s_waitcnt vmcnt(2)
    v_lshlrev_b32 v104, 16, v52
    v_and_b32 v105, 0xffff0000, v52
    v_lshlrev_b32 v106, 16, v53
    v_and_b32 v107, 0xffff0000, v53
    v_lshlrev_b32 v108, 16, v54
    v_and_b32 v109, 0xffff0000, v54
    v_lshlrev_b32 v110, 16, v55
    v_and_b32 v111, 0xffff0000, v55
    v_pk_add_f32 v[128:129], v[128:129], v[104:105]
    v_pk_fma_f32 v[132:133], v[104:105], v[104:105], v[132:133]
    v_pk_add_f32 v[130:131], v[130:131], v[106:107]
    v_pk_fma_f32 v[134:135], v[106:107], v[106:107], v[134:135]
    v_pk_add_f32 v[128:129], v[128:129], v[108:109]
    v_pk_fma_f32 v[132:133], v[108:109], v[108:109], v[132:133]
    v_pk_add_f32 v[130:131], v[130:131], v[110:111]
    v_pk_fma_f32 v[134:135], v[110:111], v[110:111], v[134:135]
    s_waitcnt vmcnt(1)
    v_lshlrev_b32 v112, 16, v56
    v_and_b32 v113, 0xffff0000, v56
    v_lshlrev_b32 v114, 16, v57
    v_and_b32 v115, 0xffff0000, v57
    v_lshlrev_b32 v116, 16, v58
    v_and_b32 v117, 0xffff0000, v58
    v_lshlrev_b32 v118, 16, v59
    v_and_b32 v119, 0xffff0000, v59
    v_pk_add_f32 v[128:129], v[128:129], v[112:113]
    v_pk_fma_f32 v[132:133], v[112:113], v[112:113], v[132:133]
    v_pk_add_f32 v[130:131], v[130:131], v[114:115]
    v_pk_fma_f32 v[134:135], v[114:115], v[114:115], v[134:135]
    v_pk_add_f32 v[128:129], v[128:129], v[116:117]
    v_pk_fma_f32 v[132:133], v[116:117], v[116:117], v[132:133]
    v_pk_add_f32 v[130:131], v[130:131], v[118:119]
    v_pk_fma_f32 v[134:135], v[118:119], v[118:119], v[134:135]
    s_waitcnt vmcnt(0)
    s_cmp_ge_u32 s40, 4
    s_cbranch_scc1 L_NNL
    buffer_load_dword v14, v15, s[36:39], 0 offen sc1
L_NNL:
    v_lshlrev_b32 v120, 16, v60
    v_and_b32 v121, 0xffff0000, v60
    v_lshlrev_b32 v122, 16, v61
    v_and_b32 v123, 0xffff0000, v61
    v_lshlrev_b32 v124, 16, v62
    v_and_b32 v125, 0xffff0000, v62
    v_lshlrev_b32 v126, 16, v63
    v_and_b32 v127, 0xffff0000, v63
    v_pk_add_f32 v[128:129], v[128:129], v[120:121]
    v_pk_fma_f32 v[132:133], v[120:121], v[120:121], v[132:133]
    v_pk_add_f32 v[130:131], v[130:131], v[122:123]
    v_pk_fma_f32 v[134:135], v[122:123], v[122:123], v[134:135]
    v_pk_add_f32 v[128:129], v[128:129], v[124:125]
    v_pk_fma_f32 v[132:133], v[124:125], v[124:125], v[132:133]
    v_pk_add_f32 v[130:131], v[130:131], v[126:127]
    v_pk_fma_f32 v[134:135], v[126:127], v[126:127], v[134:135]
L_LN2:
    v_pk_add_f32 v[128:129], v[128:129], v[130:131]
    v_pk_add_f32 v[132:133], v[132:133], v[134:135]
    v_add_f32 v128, v128, v129
    v_add_f32 v132, v132, v133
    s_nop 1
    v_add_f32_dpp v128, v128, v128 quad_perm:[1,0,3,2] row_mask:0xf bank_mask:0xf
    v_add_f32_dpp v132, v132, v132 quad_perm:[1,0,3,2] row_mask:0xf bank_mask:0xf
    s_nop 1
    v_add_f32_dpp v128, v128, v128 quad_perm:[2,3,0,1] row_mask:0xf bank_mask:0xf
    v_add_f32_dpp v132, v132, v132 quad_perm:[2,3,0,1] row_mask:0xf bank_mask:0xf
    s_nop 1
    v_add_f32_dpp v128, v128, v128 row_half_mirror row_mask:0xf bank_mask:0xf
    v_add_f32_dpp v132, v132, v132 row_half_mirror row_mask:0xf bank_mask:0xf
    v_mul_f32 v128, 0x3b000000, v128
    v_mul_f32 v132, 0x3b000000, v132
    v_fma_f32 v132, -v128, v128, v132
    v_max_f32 v132, 0, v132
    v_add_f32 v132, 0x3727c5ac, v132
    v_rsq_f32 v132, v132
    s_nop 0
    v_mul_f32_e64 v128, -v128, v132
    v_pk_fma_f32 v[64:65], v[64:65], v[132:133], v[128:129] op_sel_hi:[1,0,0]
    v_pk_fma_f32 v[66:67], v[66:67], v[132:133], v[128:129] op_sel_hi:[1,0,0]
    v_pk_fma_f32 v[68:69], v[68:69], v[132:133], v[128:129] op_sel_hi:[1,0,0]
    v_pk_fma_f32 v[70:71], v[70:71], v[132:133], v[128:129] op_sel_hi:[1,0,0]
    v_cvt_pk_bf16_f32 v32, v64, v65
    v_cvt_pk_bf16_f32 v33, v66, v67
    v_cvt_pk_bf16_f32 v34, v68, v69
    v_cvt_pk_bf16_f32 v35, v70, v71
    ds_write_b128 v7, v[32:35] offset:0
    v_pk_fma_f32 v[72:73], v[72:73], v[132:133], v[128:129] op_sel_hi:[1,0,0]
    v_pk_fma_f32 v[74:75], v[74:75], v[132:133], v[128:129] op_sel_hi:[1,0,0]
    v_pk_fma_f32 v[76:77], v[76:77], v[132:133], v[128:129] op_sel_hi:[1,0,0]
    v_pk_fma_f32 v[78:79], v[78:79], v[132:133], v[128:129] op_sel_hi:[1,0,0]
    v_cvt_pk_bf16_f32 v36, v72, v73
    v_cvt_pk_bf16_f32 v37, v74, v75
    v_cvt_pk_bf16_f32 v38, v76, v77
    v_cvt_pk_bf16_f32 v39, v78, v79
    ds_write_b128 v7, v[36:39] offset:128
    v_pk_fma_f32 v[80:81], v[80:81], v[132:133], v[128:129] op_sel_hi:[1,0,0]
    v_pk_fma_f32 v[82:83], v[82:83], v[132:133], v[128:129] op_sel_hi:[1,0,0]
    v_pk_fma_f32 v[84:85], v[84:85], v[132:133], v[128:129] op_sel_hi:[1,0,0]
    v_pk_fma_f32 v[86:87], v[86:87], v[132:133], v[128:129] op_sel_hi:[1,0,0]
    v_cvt_pk_bf16_f32 v40, v80, v81
    v_cvt_pk_bf16_f32 v41, v82, v83
    v_cvt_pk_bf16_f32 v42, v84, v85
    v_cvt_pk_bf16_f32 v43, v86, v87
    ds_write_b128 v7, v[40:43] offset:256
    v_pk_fma_f32 v[88:89], v[88:89], v[132:133], v[128:129] op_sel_hi:[1,0,0]
    v_pk_fma_f32 v[90:91], v[90:91], v[132:133], v[128:129] op_sel_hi:[1,0,0]
    v_pk_fma_f32 v[92:93], v[92:93], v[132:133], v[128:129] op_sel_hi:[1,0,0]
    v_pk_fma_f32 v[94:95], v[94:95], v[132:133], v[128:129] op_sel_hi:[1,0,0]
    v_cvt_pk_bf16_f32 v44, v88, v89
    v_cvt_pk_bf16_f32 v45, v90, v91
    v_cvt_pk_bf16_f32 v46, v92, v93
    v_cvt_pk_bf16_f32 v47, v94, v95
    ds_write_b128 v7, v[44:47] offset:384
    v_pk_fma_f32 v[96:97], v[96:97], v[132:133], v[128:129] op_sel_hi:[1,0,0]
    v_pk_fma_f32 v[98:99], v[98:99], v[132:133], v[128:129] op_sel_hi:[1,0,0]
    v_pk_fma_f32 v[100:101], v[100:101], v[132:133], v[128:129] op_sel_hi:[1,0,0]
    v_pk_fma_f32 v[102:103], v[102:103], v[132:133], v[128:129] op_sel_hi:[1,0,0]
    v_cvt_pk_bf16_f32 v48, v96, v97
    v_cvt_pk_bf16_f32 v49, v98, v99
    v_cvt_pk_bf16_f32 v50, v100, v101
    v_cvt_pk_bf16_f32 v51, v102, v103
    ds_write_b128 v7, v[48:51] offset:512
    v_pk_fma_f32 v[104:105], v[104:105], v[132:133], v[128:129] op_sel_hi:[1,0,0]
    v_pk_fma_f32 v[106:107], v[106:107], v[132:133], v[128:129] op_sel_hi:[1,0,0]
    v_pk_fma_f32 v[108:109], v[108:109], v[132:133], v[128:129] op_sel_hi:[1,0,0]
    v_pk_fma_f32 v[110:111], v[110:111], v[132:133], v[128:129] op_sel_hi:[1,0,0]
    v_cvt_pk_bf16_f32 v52, v104, v105
    v_cvt_pk_bf16_f32 v53, v106, v107
    v_cvt_pk_bf16_f32 v54, v108, v109
    v_cvt_pk_bf16_f32 v55, v110, v111
    ds_write_b128 v7, v[52:55] offset:640
    v_pk_fma_f32 v[112:113], v[112:113], v[132:133], v[128:129] op_sel_hi:[1,0,0]
    v_pk_fma_f32 v[114:115], v[114:115], v[132:133], v[128:129] op_sel_hi:[1,0,0]
    v_pk_fma_f32 v[116:117], v[116:117], v[132:133], v[128:129] op_sel_hi:[1,0,0]
    v_pk_fma_f32 v[118:119], v[118:119], v[132:133], v[128:129] op_sel_hi:[1,0,0]
    v_cvt_pk_bf16_f32 v56, v112, v113
    v_cvt_pk_bf16_f32 v57, v114, v115
    v_cvt_pk_bf16_f32 v58, v116, v117
    v_cvt_pk_bf16_f32 v59, v118, v119
    ds_write_b128 v7, v[56:59] offset:768
    v_pk_fma_f32 v[120:121], v[120:121], v[132:133], v[128:129] op_sel_hi:[1,0,0]
    v_pk_fma_f32 v[122:123], v[122:123], v[132:133], v[128:129] op_sel_hi:[1,0,0]
    v_pk_fma_f32 v[124:125], v[124:125], v[132:133], v[128:129] op_sel_hi:[1,0,0]
    v_pk_fma_f32 v[126:127], v[126:127], v[132:133], v[128:129] op_sel_hi:[1,0,0]
    v_cvt_pk_bf16_f32 v60, v120, v121
    v_cvt_pk_bf16_f32 v61, v122, v123
    v_cvt_pk_bf16_f32 v62, v124, v125
    v_cvt_pk_bf16_f32 v63, v126, v127
    ds_write_b128 v7, v[60:63] offset:896
    s_waitcnt lgkmcnt(0)
    s_mov_b64 exec, 1
    ds_add_u32 v2, v3 offset:48
    s_mov_b64 exec, -1
    s_cmp_lt_u32 s40, 4
    s_cbranch_scc1 L_A_PRE
    s_cmp_lg_u32 s97, 0
    s_cbranch_scc1 L_G_NP
    s_setprio 3
    s_mov_b32 s47, 32768
WC_1:
    ds_read_b32 v4, v2 offset:48
    s_waitcnt lgkmcnt(0)
    v_readfirstlane_b32 s43, v4
    s_sub_u32 s47, s47, 1
    s_cbranch_scc1 WD_2
    s_cmp_ge_u32 s43, 8
    s_cbranch_scc1 WD_2
    s_branch WC_1
WD_2:
    s_cmp_lg_u32 s42, 0
    s_cbranch_scc1 L_V
    ds_read_b128 v[32:35], v136 offset:0
    ds_read_b64_tr_b16 v[36:37], v137 offset:0
    ds_read_b64_tr_b16 v[38:39], v137 offset:128
    ds_read_b128 v[40:43], v136 offset:16
    ds_read_b64_tr_b16 v[44:45], v137 offset:256
    ds_read_b64_tr_b16 v[46:47], v137 offset:384
    ds_read_b128 v[48:51], v136 offset:32
    ds_read_b64_tr_b16 v[52:53], v137 offset:512
    ds_read_b64_tr_b16 v[54:55], v137 offset:640
    ds_read_b128 v[56:59], v136 offset:48
    ds_read_b64_tr_b16 v[60:61], v137 offset:768
    ds_read_b64_tr_b16 v[62:63], v137 offset:896
    s_waitcnt lgkmcnt(9)
    v_mfma_f32_16x16x32_bf16 v[128:131], v[36:39], v[32:35], 0
    ds_read_b128 v[64:67], v136 offset:64
    ds_read_b64_tr_b16 v[68:69], v137 offset:1024
    ds_read_b64_tr_b16 v[70:71], v137 offset:1152
    s_waitcnt lgkmcnt(9)
    v_mfma_f32_16x16x32_bf16 v[128:131], v[44:47], v[40:43], v[128:131]
    ds_read_b128 v[32:35], v136 offset:80
    ds_read_b64_tr_b16 v[36:37], v137 offset:1280
    ds_read_b64_tr_b16 v[38:39], v137 offset:1408
    s_waitcnt lgkmcnt(9)
    v_mfma_f32_16x16x32_bf16 v[128:131], v[52:55], v[48:51], v[128:131]
    ds_read_b128 v[40:43], v136 offset:96
    ds_read_b64_tr_b16 v[44:45], v137 offset:1536
    ds_read_b64_tr_b16 v[46:47], v137 offset:1664
    s_waitcnt lgkmcnt(9)
    v_mfma_f32_16x16x32_bf16 v[128:131], v[60:63], v[56:59], v[128:131]
    ds_read_b128 v[48:51], v136 offset:112
    ds_read_b64_tr_b16 v[52:53], v137 offset:1792
    ds_read_b64_tr_b16 v[54:55], v137 offset:1920
    s_waitcnt lgkmcnt(9)
    v_mfma_f32_16x16x32_bf16 v[128:131], v[68:71], v[64:67], v[128:131]
    ds_read_b128 v[56:59], v136 offset:128
    ds_read_b64_tr_b16 v[60:61], v137 offset:2048
    ds_read_b64_tr_b16 v[62:63], v137 offset:2176
    s_waitcnt lgkmcnt(9)
    v_mfma_f32_16x16x32_bf16 v[128:131], v[36:39], v[32:35], v[128:131]
    ds_read_b128 v[64:67], v136 offset:144
    ds_read_b64_tr_b16 v[68:69], v137 offset:2304
    ds_read_b64_tr_b16 v[70:71], v137 offset:2432
    s_waitcnt lgkmcnt(9)
    v_mfma_f32_16x16x32_bf16 v[128:131], v[44:47], v[40:43], v[128:131]
    ds_read_b128 v[32:35], v136 offset:160
    ds_read_b64_tr_b16 v[36:37], v137 offset:2560
    ds_read_b64_tr_b16 v[38:39], v137 offset:2688
    s_waitcnt lgkmcnt(9)
    v_mfma_f32_16x16x32_bf16 v[128:131], v[52:55], v[48:51], v[128:131]
    ds_read_b128 v[40:43], v136 offset:176
    ds_read_b64_tr_b16 v[44:45], v137 offset:2816
    ds_read_b64_tr_b16 v[46:47], v137 offset:2944
    s_waitcnt lgkmcnt(9)
    v_mfma_f32_16x16x32_bf16 v[128:131], v[60:63], v[56:59], v[128:131]
    ds_read_b128 v[48:51], v136 offset:192
    ds_read_b64_tr_b16 v[52:53], v137 offset:3072
    ds_read_b64_tr_b16 v[54:55], v137 offset:3200
    s_waitcnt lgkmcnt(9)
    v_mfma_f32_16x16x32_bf16 v[128:131], v[68:71], v[64:67], v[128:131]
    ds_read_b128 v[56:59], v136 offset:208
    ds_read_b64_tr_b16 v[60:61], v137 offset:3328
    ds_read_b64_tr_b16 v[62:63], v137 offset:3456
    s_waitcnt lgkmcnt(9)
    v_mfma_f32_16x16x32_bf16 v[128:131], v[36:39], v[32:35], v[128:131]
    ds_read_b128 v[64:67], v136 offset:224
    ds_read_b64_tr_b16 v[68:69], v137 offset:3584
    ds_read_b64_tr_b16 v[70:71], v137 offset:3712
    s_waitcnt lgkmcnt(9)
    v_mfma_f32_16x16x32_bf16 v[128:131], v[44:47], v[40:43], v[128:131]
    ds_read_b128 v[32:35], v136 offset:240
    ds_read_b64_tr_b16 v[36:37], v137 offset:3840
    ds_read_b64_tr_b16 v[38:39], v137 offset:3968
    s_waitcnt lgkmcnt(9)
    v_mfma_f32_16x16x32_bf16 v[128:131], v[52:55], v[48:51], v[128:131]
    s_waitcnt lgkmcnt(6)
    v_mfma_f32_16x16x32_bf16 v[128:131], v[60:63], v[56:59], v[128:131]
    s_waitcnt lgkmcnt(3)
    v_mfma_f32_16x16x32_bf16 v[128:131], v[68:71], v[64:67], v[128:131]
    s_waitcnt lgkmcnt(0)
    v_mfma_f32_16x16x32_bf16 v[128:131], v[36:39], v[32:35], v[128:131]
    s_nop 1
    s_branch L_KVS
L_V:
    ds_read_b128 v[32:35], v136 offset:0
    ds_read_b64_tr_b16 v[36:37], v137 offset:0
    ds_read_b64_tr_b16 v[38:39], v137 offset:128
    ds_read_b128 v[40:43], v136 offset:16
    ds_read_b64_tr_b16 v[44:45], v137 offset:256
    ds_read_b64_tr_b16 v[46:47], v137 offset:384
    ds_read_b128 v[48:51], v136 offset:32
    ds_read_b64_tr_b16 v[52:53], v137 offset:512
    ds_read_b64_tr_b16 v[54:55], v137 offset:640
    ds_read_b128 v[56:59], v136 offset:48
    ds_read_b64_tr_b16 v[60:61], v137 offset:768
    ds_read_b64_tr_b16 v[62:63], v137 offset:896
    s_waitcnt lgkmcnt(9)
    v_mfma_f32_16x16x32_bf16 v[128:131], v[32:35], v[36:39], 0
    ds_read_b128 v[64:67], v136 offset:64
    ds_read_b64_tr_b16 v[68:69], v137 offset:1024
    ds_read_b64_tr_b16 v[70:71], v137 offset:1152
    s_waitcnt lgkmcnt(9)
    v_mfma_f32_16x16x32_bf16 v[128:131], v[40:43], v[44:47], v[128:131]
    ds_read_b128 v[32:35], v136 offset:80
    ds_read_b64_tr_b16 v[36:37], v137 offset:1280
    ds_read_b64_tr_b16 v[38:39], v137 offset:1408
    s_waitcnt lgkmcnt(9)
    v_mfma_f32_16x16x32_bf16 v[128:131], v[48:51], v[52:55], v[128:131]
    ds_read_b128 v[40:43], v136 offset:96
    ds_read_b64_tr_b16 v[44:45], v137 offset:1536
    ds_read_b64_tr_b16 v[46:47], v137 offset:1664
    s_waitcnt lgkmcnt(9)
    v_mfma_f32_16x16x32_bf16 v[128:131], v[56:59], v[60:63], v[128:131]
    ds_read_b128 v[48:51], v136 offset:112
    ds_read_b64_tr_b16 v[52:53], v137 offset:1792
    ds_read_b64_tr_b16 v[54:55], v137 offset:1920
    s_waitcnt lgkmcnt(9)
    v_mfma_f32_16x16x32_bf16 v[128:131], v[64:67], v[68:71], v[128:131]
    ds_read_b128 v[56:59], v136 offset:128
    ds_read_b64_tr_b16 v[60:61], v137 offset:2048
    ds_read_b64_tr_b16 v[62:63], v137 offset:2176
    s_waitcnt lgkmcnt(9)
    v_mfma_f32_16x16x32_bf16 v[128:131], v[32:35], v[36:39], v[128:131]
    ds_read_b128 v[64:67], v136 offset:144
    ds_read_b64_tr_b16 v[68:69], v137 offset:2304
    ds_read_b64_tr_b16 v[70:71], v137 offset:2432
    s_waitcnt lgkmcnt(9)
    v_mfma_f32_16x16x32_bf16 v[128:131], v[40:43], v[44:47], v[128:131]
    ds_read_b128 v[32:35], v136 offset:160
    ds_read_b64_tr_b16 v[36:37], v137 offset:2560
    ds_read_b64_tr_b16 v[38:39], v137 offset:2688
    s_waitcnt lgkmcnt(9)
    v_mfma_f32_16x16x32_bf16 v[128:131], v[48:51], v[52:55], v[128:131]
    ds_read_b128 v[40:43], v136 offset:176
    ds_read_b64_tr_b16 v[44:45], v137 offset:2816
    ds_read_b64_tr_b16 v[46:47], v137 offset:2944
    s_waitcnt lgkmcnt(9)
    v_mfma_f32_16x16x32_bf16 v[128:131], v[56:59], v[60:63], v[128:131]
    ds_read_b128 v[48:51], v136 offset:192
    ds_read_b64_tr_b16 v[52:53], v137 offset:3072
    ds_read_b64_tr_b16 v[54:55], v137 offset:3200
    s_waitcnt lgkmcnt(9)
    v_mfma_f32_16x16x32_bf16 v[128:131], v[64:67], v[68:71], v[128:131]
    ds_read_b128 v[56:59], v136 offset:208
    ds_read_b64_tr_b16 v[60:61], v137 offset:3328
    ds_read_b64_tr_b16 v[62:63], v137 offset:3456
    s_waitcnt lgkmcnt(9)
    v_mfma_f32_16x16x32_bf16 v[128:131], v[32:35], v[36:39], v[128:131]
    ds_read_b128 v[64:67], v136 offset:224
    ds_read_b64_tr_b16 v[68:69], v137 offset:3584
    ds_read_b64_tr_b16 v[70:71], v137 offset:3712
    s_waitcnt lgkmcnt(9)
    v_mfma_f32_16x16x32_bf16 v[128:131], v[40:43], v[44:47], v[128:131]
    ds_read_b128 v[32:35], v136 offset:240
    ds_read_b64_tr_b16 v[36:37], v137 offset:3840
    ds_read_b64_tr_b16 v[38:39], v137 offset:3968
    s_waitcnt lgkmcnt(9)
    v_mfma_f32_16x16x32_bf16 v[128:131], v[48:51], v[52:55], v[128:131]
    s_waitcnt lgkmcnt(6)
    v_mfma_f32_16x16x32_bf16 v[128:131], v[56:59], v[60:63], v[128:131]
    s_waitcnt lgkmcnt(3)
    v_mfma_f32_16x16x32_bf16 v[128:131], v[64:67], v[68:71], v[128:131]
    s_waitcnt lgkmcnt(0)
    v_mfma_f32_16x16x32_bf16 v[128:131], v[32:35], v[36:39], v[128:131]
    s_mov_b64 exec, 0xf
    buffer_store_dwordx2 v[140:141], v139, s[12:15], s3 offen offset:512 sc1
    s_mov_b64 exec, -1
L_KVS:
    s_nop 5
    v_cvt_pk_bf16_f32 v132, v128, v129
    v_cvt_pk_bf16_f32 v133, v130, v131
    buffer_store_dwordx2 v[132:133], v138, s[12:15], s3 offen sc1
    buffer_load_dword v14, v15, s[36:39], 0 offen sc1
    s_mov_b64 exec, 1
    ds_add_u32 v2, v3 offset:16
    s_mov_b64 exec, -1
    s_lshl_b32 s44, s41, 8
    s_lshl_b32 s45, s42, 5
    s_add_u32 s44, s44, s45
    s_add_u32 s44, s44, 262144
    s_waitcnt vmcnt(0)
    s_mov_b64 exec, 1
    ds_add_rtn_u32 v4, v2, v3 offset:20
    s_mov_b64 exec, -1
    s_mov_b32 s47, 32768
GN_3:
    v_readfirstlane_b32 s100, v14
    s_sub_u32 s47, s47, 1
    s_cbranch_scc1 GD_4
    s_cmp_lg_u32 s100, 0
    s_cbranch_scc1 GD_4
    buffer_load_dword v14, v15, s[36:39], 0 offen sc1
    s_waitcnt vmcnt(0)
    s_branch GN_3
GD_4:
    s_mov_b32 s101, s100
    s_waitcnt lgkmcnt(0)
    v_readfirstlane_b32 s43, v4
    s_nop 3
    s_cmp_lg_u32 s43, 3
    s_cbranch_scc1 L_G_NF
    v_lshlrev_b32 v4, 13, v1
    s_mov_b64 exec, 65535
    buffer_store_dword v14, v4, s[12:15], s44 offen sc1
    s_mov_b64 exec, -1
    s_mov_b64 exec, 1
    ds_add_u32 v2, v3 offset:44
    s_mov_b64 exec, -1
L_G_NF:
    s_mov_b32 s47, 32768
WC_5:
    ds_read_b32 v4, v2 offset:44
    s_waitcnt lgkmcnt(0)
    v_readfirstlane_b32 s43, v4
    s_sub_u32 s47, s47, 1
    s_cbranch_scc1 WD_6
    s_cmp_ge_u32 s43, 1
    s_cbranch_scc1 WD_6
    s_branch WC_5
WD_6:
    s_add_u32 m0, s46, 0
    s_nop 0
    buffer_load_dwordx4 v9, s[32:35], s48 offen lds
    buffer_load_dwordx4 v10, s[32:35], s48 offen offset:1024 lds
    s_add_u32 s48, s48, s49
    s_add_u32 m0, s46, 2048
    s_nop 0
    buffer_load_dwordx4 v9, s[32:35], s48 offen lds
    buffer_load_dwordx4 v10, s[32:35], s48 offen offset:1024 lds
    s_add_u32 s48, s48, s49
    s_add_u32 m0, s46, 4096
    s_nop 0
    buffer_load_dwordx4 v9, s[32:35], s48 offen lds
    buffer_load_dwordx4 v10, s[32:35], s48 offen offset:1024 lds
    s_add_u32 s48, s48, s49
L_G_NP:
    s_setprio 2
    buffer_load_dword v14, v15, s[36:39], 0 offen sc1
    s_mov_b32 s47, 32768
WC_7:
    ds_read_b32 v4, v2 offset:48
    s_waitcnt lgkmcnt(0)
    v_readfirstlane_b32 s43, v4
    s_sub_u32 s47, s47, 1
    s_cbranch_scc1 WD_8
    s_cmp_ge_u32 s43, 8
    s_cbranch_scc1 WD_8
    s_branch WC_7
WD_8:
    v_and_b32 v25, 31, v1
    v_mul_u32_u24 v11, 1040, v25
    v_lshl_add_u32 v11, v24, 4, v11
    v_add_u32 v11, 67584, v11
    s_cmp_eq_u32 s97, 0
    s_cbranch_scc1 L_G1_N
    v_lshl_add_u32 v12, v24, 10, v23
    v_add_u32 v12, s46, v12
    s_waitcnt vmcnt(5)
    ds_read_b128 v[32:35], v11 offset:0
    ds_read_b128 v[36:39], v11 offset:33280
    ds_read_b64_tr_b16 v[40:41], v12 offset:0
    ds_read_b64_tr_b16 v[42:43], v12 offset:512
    ds_read_b64_tr_b16 v[44:45], v12 offset:256
    ds_read_b64_tr_b16 v[46:47], v12 offset:768
    s_waitcnt vmcnt(3)
    ds_read_b128 v[48:51], v11 offset:32
    ds_read_b128 v[52:55], v11 offset:33312
    ds_read_b64_tr_b16 v[56:57], v12 offset:2048
    ds_read_b64_tr_b16 v[58:59], v12 offset:2560
    ds_read_b64_tr_b16 v[60:61], v12 offset:2304
    ds_read_b64_tr_b16 v[62:63], v12 offset:2816
    s_waitcnt lgkmcnt(6)
    s_setprio 0
    v_mfma_f32_32x32x16_bf16 v[128:143], v[40:43], v[32:35], 0
    s_setprio 2
    s_add_u32 m0, s46, 0
    s_nop 0
    buffer_load_dwordx4 v9, s[32:35], s48 offen lds
    buffer_load_dwordx4 v10, s[32:35], s48 offen offset:1024 lds
    s_add_u32 s48, s48, s49
    s_setprio 0
    v_mfma_f32_32x32x16_bf16 v[144:159], v[40:43], v[36:39], 0
    s_setprio 2
    s_waitcnt vmcnt(3)
    ds_read_b128 v[64:67], v11 offset:64
    ds_read_b128 v[68:71], v11 offset:33344
    s_setprio 0
    v_mfma_f32_32x32x16_bf16 v[160:175], v[44:47], v[32:35], 0
    s_setprio 2
    ds_read_b64_tr_b16 v[72:73], v12 offset:4096
    ds_read_b64_tr_b16 v[74:75], v12 offset:4608
    ds_read_b64_tr_b16 v[76:77], v12 offset:4352
    ds_read_b64_tr_b16 v[78:79], v12 offset:4864
    s_setprio 0
    v_mfma_f32_32x32x16_bf16 v[176:191], v[44:47], v[36:39], 0
    s_setprio 2
    s_waitcnt lgkmcnt(6)
    s_setprio 0
    v_mfma_f32_32x32x16_bf16 v[128:143], v[56:59], v[48:51], v[128:143]
    s_setprio 2
    s_add_u32 m0, s46, 2048
    s_nop 0
    buffer_load_dwordx4 v9, s[32:35], s48 offen lds
    buffer_load_dwordx4 v10, s[32:35], s48 offen offset:1024 lds
    s_add_u32 s48, s48, s49
    s_setprio 0
    v_mfma_f32_32x32x16_bf16 v[144:159], v[56:59], v[52:55], v[144:159]
    s_setprio 2
    s_waitcnt vmcnt(2)
    ds_read_b128 v[32:35], v11 offset:96
    ds_read_b128 v[36:39], v11 offset:33376
    s_setprio 0
    v_mfma_f32_32x32x16_bf16 v[160:175], v[60:63], v[48:51], v[160:175]
    s_setprio 2
    ds_read_b64_tr_b16 v[40:41], v12 offset:0
    ds_read_b64_tr_b16 v[42:43], v12 offset:512
    ds_read_b64_tr_b16 v[44:45], v12 offset:256
    ds_read_b64_tr_b16 v[46:47], v12 offset:768
    s_setprio 0
    v_mfma_f32_32x32x16_bf16 v[176:191], v[60:63], v[52:55], v[176:191]
    s_setprio 2
    s_waitcnt lgkmcnt(6)
    s_setprio 0
    v_mfma_f32_32x32x16_bf16 v[128:143], v[72:75], v[64:67], v[128:143]
    s_setprio 2
    s_add_u32 m0, s46, 4096
    s_nop 0
    buffer_load_dwordx4 v9, s[32:35], s48 offen lds
    buffer_load_dwordx4 v10, s[32:35], s48 offen offset:1024 lds
    s_add_u32 s48, s48, s49
    s_setprio 0
    v_mfma_f32_32x32x16_bf16 v[144:159], v[72:75], v[68:71], v[144:159]
    s_setprio 2
    s_waitcnt vmcnt(2)
    ds_read_b128 v[48:51], v11 offset:128
    ds_read_b128 v[52:55], v11 offset:33408
    s_setprio 0
    v_mfma_f32_32x32x16_bf16 v[160:175], v[76:79], v[64:67], v[160:175]
    s_setprio 2
    ds_read_b64_tr_b16 v[56:57], v12 offset:2048
    ds_read_b64_tr_b16 v[58:59], v12 offset:2560
    ds_read_b64_tr_b16 v[60:61], v12 offset:2304
    ds_read_b64_tr_b16 v[62:63], v12 offset:2816
    s_setprio 0
    v_mfma_f32_32x32x16_bf16 v[176:191], v[76:79], v[68:71], v[176:191]
    s_setprio 2
    s_waitcnt lgkmcnt(6)
    s_setprio 0
    v_mfma_f32_32x32x16_bf16 v[128:143], v[40:43], v[32:35], v[128:143]
    s_setprio 2
    s_add_u32 m0, s46, 0
    s_nop 0
    buffer_load_dwordx4 v9, s[32:35], s48 offen lds
    buffer_load_dwordx4 v10, s[32:35], s48 offen offset:1024 lds
    s_add_u32 s48, s48, s49
    s_setprio 0
    v_mfma_f32_32x32x16_bf16 v[144:159], v[40:43], v[36:39], v[144:159]
    s_setprio 2
    s_waitcnt vmcnt(2)
    ds_read_b128 v[64:67], v11 offset:160
    ds_read_b128 v[68:71], v11 offset:33440
    s_setprio 0
    v_mfma_f32_32x32x16_bf16 v[160:175], v[44:47], v[32:35], v[160:175]
    s_setprio 2
    ds_read_b64_tr_b16 v[72:73], v12 offset:4096
    ds_read_b64_tr_b16 v[74:75], v12 offset:4608
    ds_read_b64_tr_b16 v[76:77], v12 offset:4352
    ds_read_b64_tr_b16 v[78:79], v12 offset:4864
    s_setprio 0
    v_mfma_f32_32x32x16_bf16 v[176:191], v[44:47], v[36:39], v[176:191]
    s_setprio 2
    s_waitcnt lgkmcnt(6)
    s_setprio 0
    v_mfma_f32_32x32x16_bf16 v[128:143], v[56:59], v[48:51], v[128:143]
    s_setprio 2
    s_add_u32 m0, s46, 2048
    s_nop 0
    buffer_load_dwordx4 v9, s[32:35], s48 offen lds
    buffer_load_dwordx4 v10, s[32:35], s48 offen offset:1024 lds
    s_add_u32 s48, s48, s49
    s_setprio 0
    v_mfma_f32_32x32x16_bf16 v[144:159], v[56:59], v[52:55], v[144:159]
    s_setprio 2
    s_waitcnt vmcnt(2)
    ds_read_b128 v[32:35], v11 offset:192
    ds_read_b128 v[36:39], v11 offset:33472
    s_setprio 0
    v_mfma_f32_32x32x16_bf16 v[160:175], v[60:63], v[48:51], v[160:175]
    s_setprio 2
    ds_read_b64_tr_b16 v[40:41], v12 offset:0
    ds_read_b64_tr_b16 v[42:43], v12 offset:512
    ds_read_b64_tr_b16 v[44:45], v12 offset:256
    ds_read_b64_tr_b16 v[46:47], v12 offset:768
    s_setprio 0
    v_mfma_f32_32x32x16_bf16 v[176:191], v[60:63], v[52:55], v[176:191]
    s_setprio 2
    s_waitcnt lgkmcnt(6)
    s_setprio 0
    v_mfma_f32_32x32x16_bf16 v[128:143], v[72:75], v[64:67], v[128:143]
    s_setprio 2
    s_add_u32 m0, s46, 4096
    s_nop 0
    buffer_load_dwordx4 v9, s[32:35], s48 offen lds
    buffer_load_dwordx4 v10, s[32:35], s48 offen offset:1024 lds
    s_add_u32 s48, s48, s49
    s_setprio 0
    v_mfma_f32_32x32x16_bf16 v[144:159], v[72:75], v[68:71], v[144:159]
    s_setprio 2
    s_waitcnt vmcnt(2)
    ds_read_b128 v[48:51], v11 offset:224
    ds_read_b128 v[52:55], v11 offset:33504
    s_setprio 0
    v_mfma_f32_32x32x16_bf16 v[160:175], v[76:79], v[64:67], v[160:175]
    s_setprio 2
    ds_read_b64_tr_b16 v[56:57], v12 offset:2048
    ds_read_b64_tr_b16 v[58:59], v12 offset:2560
    ds_read_b64_tr_b16 v[60:61], v12 offset:2304
    ds_read_b64_tr_b16 v[62:63], v12 offset:2816
    s_setprio 0
    v_mfma_f32_32x32x16_bf16 v[176:191], v[76:79], v[68:71], v[176:191]
    s_setprio 2
    s_waitcnt lgkmcnt(6)
    s_setprio 0
    v_mfma_f32_32x32x16_bf16 v[128:143], v[40:43], v[32:35], v[128:143]
    s_setprio 2
    s_add_u32 m0, s46, 0
    s_nop 0
    buffer_load_dwordx4 v9, s[32:35], s48 offen lds
    buffer_load_dwordx4 v10, s[32:35], s48 offen offset:1024 lds
    s_add_u32 s48, s48, s49
    s_setprio 0
    v_mfma_f32_32x32x16_bf16 v[144:159], v[40:43], v[36:39], v[144:159]
    s_setprio 2
    s_waitcnt vmcnt(2)
    ds_read_b128 v[64:67], v11 offset:256
    ds_read_b128 v[68:71], v11 offset:33536
    s_setprio 0
    v_mfma_f32_32x32x16_bf16 v[160:175], v[44:47], v[32:35], v[160:175]
    s_setprio 2
    ds_read_b64_tr_b16 v[72:73], v12 offset:4096
    ds_read_b64_tr_b16 v[74:75], v12 offset:4608
    ds_read_b64_tr_b16 v[76:77], v12 offset:4352
    ds_read_b64_tr_b16 v[78:79], v12 offset:4864
    s_setprio 0
    v_mfma_f32_32x32x16_bf16 v[176:191], v[44:47], v[36:39], v[176:191]
    s_setprio 2
    s_waitcnt lgkmcnt(6)
    s_setprio 0
    v_mfma_f32_32x32x16_bf16 v[128:143], v[56:59], v[48:51], v[128:143]
    s_setprio 2
    s_add_u32 m0, s46, 2048
    s_nop 0
    buffer_load_dwordx4 v9, s[32:35], s48 offen lds
    buffer_load_dwordx4 v10, s[32:35], s48 offen offset:1024 lds
    s_add_u32 s48, s48, s49
    s_setprio 0
    v_mfma_f32_32x32x16_bf16 v[144:159], v[56:59], v[52:55], v[144:159]
    s_setprio 2
    s_waitcnt vmcnt(2)
    ds_read_b128 v[32:35], v11 offset:288
    ds_read_b128 v[36:39], v11 offset:33568
    s_setprio 0
    v_mfma_f32_32x32x16_bf16 v[160:175], v[60:63], v[48:51], v[160:175]
    s_setprio 2
    ds_read_b64_tr_b16 v[40:41], v12 offset:0
    ds_read_b64_tr_b16 v[42:43], v12 offset:512
    ds_read_b64_tr_b16 v[44:45], v12 offset:256
    ds_read_b64_tr_b16 v[46:47], v12 offset:768
    s_setprio 0
    v_mfma_f32_32x32x16_bf16 v[176:191], v[60:63], v[52:55], v[176:191]
    s_setprio 2
    s_waitcnt lgkmcnt(6)
    s_setprio 0
    v_mfma_f32_32x32x16_bf16 v[128:143], v[72:75], v[64:67], v[128:143]
    s_setprio 2
    s_add_u32 m0, s46, 4096
    s_nop 0
    buffer_load_dwordx4 v9, s[32:35], s48 offen lds
    buffer_load_dwordx4 v10, s[32:35], s48 offen offset:1024 lds
    s_add_u32 s48, s48, s49
    s_setprio 0
    v_mfma_f32_32x32x16_bf16 v[144:159], v[72:75], v[68:71], v[144:159]
    s_setprio 2
    s_waitcnt vmcnt(2)
    ds_read_b128 v[48:51], v11 offset:320
    ds_read_b128 v[52:55], v11 offset:33600
    s_setprio 0
    v_mfma_f32_32x32x16_bf16 v[160:175], v[76:79], v[64:67], v[160:175]
    s_setprio 2
    ds_read_b64_tr_b16 v[56:57], v12 offset:2048
    ds_read_b64_tr_b16 v[58:59], v12 offset:2560
    ds_read_b64_tr_b16 v[60:61], v12 offset:2304
    ds_read_b64_tr_b16 v[62:63], v12 offset:2816
    s_setprio 0
    v_mfma_f32_32x32x16_bf16 v[176:191], v[76:79], v[68:71], v[176:191]
    s_setprio 2
    s_waitcnt lgkmcnt(6)
    s_setprio 0
    v_mfma_f32_32x32x16_bf16 v[128:143], v[40:43], v[32:35], v[128:143]
    s_setprio 2
    s_add_u32 m0, s46, 0
    s_nop 0
    buffer_load_dwordx4 v9, s[32:35], s48 offen lds
    buffer_load_dwordx4 v10, s[32:35], s48 offen offset:1024 lds
    s_add_u32 s48, s48, s49
    s_setprio 0
    v_mfma_f32_32x32x16_bf16 v[144:159], v[40:43], v[36:39], v[144:159]
    s_setprio 2
    s_waitcnt vmcnt(2)
    ds_read_b128 v[64:67], v11 offset:352
    ds_read_b128 v[68:71], v11 offset:33632
    s_setprio 0
    v_mfma_f32_32x32x16_bf16 v[160:175], v[44:47], v[32:35], v[160:175]
    s_setprio 2
    ds_read_b64_tr_b16 v[72:73], v12 offset:4096
    ds_read_b64_tr_b16 v[74:75], v12 offset:4608
    ds_read_b64_tr_b16 v[76:77], v12 offset:4352
    ds_read_b64_tr_b16 v[78:79], v12 offset:4864
    s_setprio 0
    v_mfma_f32_32x32x16_bf16 v[176:191], v[44:47], v[36:39], v[176:191]
    s_setprio 2
    s_waitcnt lgkmcnt(6)
    s_setprio 0
    v_mfma_f32_32x32x16_bf16 v[128:143], v[56:59], v[48:51], v[128:143]
    s_setprio 2
    s_add_u32 m0, s46, 2048
    s_nop 0
    buffer_load_dwordx4 v9, s[32:35], s48 offen lds
    buffer_load_dwordx4 v10, s[32:35], s48 offen offset:1024 lds
    s_add_u32 s48, s48, s49
    s_setprio 0
    v_mfma_f32_32x32x16_bf16 v[144:159], v[56:59], v[52:55], v[144:159]
    s_setprio 2
    s_waitcnt vmcnt(2)
    ds_read_b128 v[32:35], v11 offset:384
    ds_read_b128 v[36:39], v11 offset:33664
    s_setprio 0
    v_mfma_f32_32x32x16_bf16 v[160:175], v[60:63], v[48:51], v[160:175]
    s_setprio 2
    ds_read_b64_tr_b16 v[40:41], v12 offset:0
    ds_read_b64_tr_b16 v[42:43], v12 offset:512
    ds_read_b64_tr_b16 v[44:45], v12 offset:256
    ds_read_b64_tr_b16 v[46:47], v12 offset:768
    s_setprio 0
    v_mfma_f32_32x32x16_bf16 v[176:191], v[60:63], v[52:55], v[176:191]
    s_setprio 2
    s_waitcnt lgkmcnt(6)
    s_setprio 0
    v_mfma_f32_32x32x16_bf16 v[128:143], v[72:75], v[64:67], v[128:143]
    s_setprio 2
    s_add_u32 m0, s46, 4096
    s_nop 0
    buffer_load_dwordx4 v9, s[32:35], s48 offen lds
    buffer_load_dwordx4 v10, s[32:35], s48 offen offset:1024 lds
    s_add_u32 s48, s48, s49
    s_setprio 0
    v_mfma_f32_32x32x16_bf16 v[144:159], v[72:75], v[68:71], v[144:159]
    s_setprio 2
    s_waitcnt vmcnt(2)
    ds_read_b128 v[48:51], v11 offset:416
    ds_read_b128 v[52:55], v11 offset:33696
    s_setprio 0
    v_mfma_f32_32x32x16_bf16 v[160:175], v[76:79], v[64:67], v[160:175]
    s_setprio 2
    ds_read_b64_tr_b16 v[56:57], v12 offset:2048
    ds_read_b64_tr_b16 v[58:59], v12 offset:2560
    ds_read_b64_tr_b16 v[60:61], v12 offset:2304
    ds_read_b64_tr_b16 v[62:63], v12 offset:2816
    s_setprio 0
    v_mfma_f32_32x32x16_bf16 v[176:191], v[76:79], v[68:71], v[176:191]
    s_setprio 2
    s_waitcnt lgkmcnt(6)
    s_setprio 0
    v_mfma_f32_32x32x16_bf16 v[128:143], v[40:43], v[32:35], v[128:143]
    s_setprio 2
    s_add_u32 m0, s46, 0
    s_nop 0
    buffer_load_dwordx4 v9, s[32:35], s48 offen lds
    buffer_load_dwordx4 v10, s[32:35], s48 offen offset:1024 lds
    s_add_u32 s48, s48, s49
    s_setprio 0
    v_mfma_f32_32x32x16_bf16 v[144:159], v[40:43], v[36:39], v[144:159]
    s_setprio 2
    s_waitcnt vmcnt(2)
    ds_read_b128 v[64:67], v11 offset:448
    ds_read_b128 v[68:71], v11 offset:33728
    s_setprio 0
    v_mfma_f32_32x32x16_bf16 v[160:175], v[44:47], v[32:35], v[160:175]
    s_setprio 2
    ds_read_b64_tr_b16 v[72:73], v12 offset:4096
    ds_read_b64_tr_b16 v[74:75], v12 offset:4608
    ds_read_b64_tr_b16 v[76:77], v12 offset:4352
    ds_read_b64_tr_b16 v[78:79], v12 offset:4864
    s_setprio 0
    v_mfma_f32_32x32x16_bf16 v[176:191], v[44:47], v[36:39], v[176:191]
    s_setprio 2
    s_waitcnt lgkmcnt(6)
    s_setprio 0
    v_mfma_f32_32x32x16_bf16 v[128:143], v[56:59], v[48:51], v[128:143]
    s_setprio 2
    s_mov_b32 s47, 32768
WC_9:
    ds_read_b32 v4, v2 offset:28
    s_waitcnt lgkmcnt(0)
    v_readfirstlane_b32 s43, v4
    s_sub_u32 s47, s47, 1
    s_cbranch_scc1 WD_10
    s_cmp_ge_u32 s43, 4
    s_cbranch_scc1 WD_10
    s_sleep 1
    s_branch WC_9
WD_10:
    s_mov_b32 s50, s48
    s_lshl_b32 s43, s56, 12
    s_add_u32 s48, s43, 33792
    s_add_u32 m0, s43, 33792
    s_nop 0
    buffer_load_dwordx4 v8, s[12:15], s48 offen offset:0 sc1 lds
    buffer_load_dwordx4 v8, s[12:15], s48 offen offset:1024 sc1 lds
    buffer_load_dwordx4 v8, s[12:15], s48 offen offset:2048 sc1 lds
    buffer_load_dwordx4 v8, s[12:15], s48 offen offset:3072 sc1 lds
    s_add_u32 s48, s48, 16384
    s_add_u32 m0, m0, 16384
    s_nop 0
    buffer_load_dwordx4 v8, s[12:15], s48 offen offset:0 sc1 lds
    buffer_load_dwordx4 v8, s[12:15], s48 offen offset:1024 sc1 lds
    buffer_load_dwordx4 v8, s[12:15], s48 offen offset:2048 sc1 lds
    buffer_load_dwordx4 v8, s[12:15], s48 offen offset:3072 sc1 lds
    s_add_u32 s48, s48, 16384
    s_add_u32 m0, m0, 16384
    s_cmp_lg_u32 s56, 0
    s_cbranch_scc1 KD_11
    buffer_load_dwordx4 v8, s[12:15], s48 offen sc1 lds
KD_11:
    s_mov_b32 s48, s50
    v_mov_b64 v[120:121], -1
    v_mov_b64 v[122:123], -1
    s_lshl_b32 s43, s42, 13
    s_lshr_b32 s60, s56, 1
    s_lshl_b32 s60, s60, 12
    s_add_u32 s43, s43, s60
    s_and_b32 s60, s56, 1
    s_lshl_b32 s60, s60, 10
    s_add_u32 s43, s43, s60
    s_add_u32 s43, s43, s51
    s_add_u32 s43, s43, 229376
    buffer_store_dwordx4 v[120:123], v8, s[12:15], s43 offen sc1
    buffer_store_dwordx4 v[120:123], v8, s[12:15], s43 offen offset:2048 sc1
    s_add_u32 m0, s46, 2048
    s_nop 0
    buffer_load_dwordx4 v9, s[32:35], s48 offen lds
    buffer_load_dwordx4 v10, s[32:35], s48 offen offset:1024 lds
    s_add_u32 s48, s48, s49
    s_setprio 0
    v_mfma_f32_32x32x16_bf16 v[144:159], v[56:59], v[52:55], v[144:159]
    s_setprio 2
    s_waitcnt vmcnt(12)
    ds_read_b128 v[32:35], v11 offset:480
    ds_read_b128 v[36:39], v11 offset:33760
    s_setprio 0
    v_mfma_f32_32x32x16_bf16 v[160:175], v[60:63], v[48:51], v[160:175]
    s_setprio 2
    ds_read_b64_tr_b16 v[40:41], v12 offset:0
    ds_read_b64_tr_b16 v[42:43], v12 offset:512
    ds_read_b64_tr_b16 v[44:45], v12 offset:256
    ds_read_b64_tr_b16 v[46:47], v12 offset:768
    s_setprio 0
    v_mfma_f32_32x32x16_bf16 v[176:191], v[60:63], v[52:55], v[176:191]
    s_setprio 2
    s_waitcnt lgkmcnt(6)
    s_setprio 0
    v_mfma_f32_32x32x16_bf16 v[128:143], v[72:75], v[64:67], v[128:143]
    s_setprio 2
    s_add_u32 m0, s46, 4096
    s_nop 0
    buffer_load_dwordx4 v9, s[32:35], s48 offen lds
    buffer_load_dwordx4 v10, s[32:35], s48 offen offset:1024 lds
    s_add_u32 s48, s48, s49
    s_setprio 0
    v_mfma_f32_32x32x16_bf16 v[144:159], v[72:75], v[68:71], v[144:159]
    s_setprio 2
    s_waitcnt vmcnt(2)
    s_mov_b64 exec, 1
    ds_add_u32 v2, v3 offset:0
    s_mov_b64 exec, -1
    ds_read_b128 v[48:51], v11 offset:512
    ds_read_b128 v[52:55], v11 offset:33792
    s_setprio 0
    v_mfma_f32_32x32x16_bf16 v[160:175], v[76:79], v[64:67], v[160:175]
    s_setprio 2
    ds_read_b64_tr_b16 v[56:57], v12 offset:2048
    ds_read_b64_tr_b16 v[58:59], v12 offset:2560
    ds_read_b64_tr_b16 v[60:61], v12 offset:2304
    ds_read_b64_tr_b16 v[62:63], v12 offset:2816
    s_setprio 0
    v_mfma_f32_32x32x16_bf16 v[176:191], v[76:79], v[68:71], v[176:191]
    s_setprio 2
    s_waitcnt lgkmcnt(6)
    s_setprio 0
    v_mfma_f32_32x32x16_bf16 v[128:143], v[40:43], v[32:35], v[128:143]
    s_setprio 2
    s_add_u32 m0, s46, 0
    s_nop 0
    buffer_load_dwordx4 v9, s[32:35], s48 offen lds
    buffer_load_dwordx4 v10, s[32:35], s48 offen offset:1024 lds
    s_add_u32 s48, s48, s49
    s_setprio 0
    v_mfma_f32_32x32x16_bf16 v[144:159], v[40:43], v[36:39], v[144:159]
    s_setprio 2
    s_waitcnt vmcnt(2)
    ds_read_b128 v[64:67], v11 offset:544
    ds_read_b128 v[68:71], v11 offset:33824
    s_setprio 0
    v_mfma_f32_32x32x16_bf16 v[160:175], v[44:47], v[32:35], v[160:175]
    s_setprio 2
    ds_read_b64_tr_b16 v[72:73], v12 offset:4096
    ds_read_b64_tr_b16 v[74:75], v12 offset:4608
    ds_read_b64_tr_b16 v[76:77], v12 offset:4352
    ds_read_b64_tr_b16 v[78:79], v12 offset:4864
    s_setprio 0
    v_mfma_f32_32x32x16_bf16 v[176:191], v[44:47], v[36:39], v[176:191]
    s_setprio 2
    s_waitcnt lgkmcnt(6)
    s_setprio 0
    v_mfma_f32_32x32x16_bf16 v[128:143], v[56:59], v[48:51], v[128:143]
    s_setprio 2
    s_add_u32 m0, s46, 2048
    s_nop 0
    buffer_load_dwordx4 v9, s[32:35], s48 offen lds
    buffer_load_dwordx4 v10, s[32:35], s48 offen offset:1024 lds
    s_add_u32 s48, s48, s49
    s_setprio 0
    v_mfma_f32_32x32x16_bf16 v[144:159], v[56:59], v[52:55], v[144:159]
    s_setprio 2
    s_waitcnt vmcnt(2)
    ds_read_b128 v[32:35], v11 offset:576
    ds_read_b128 v[36:39], v11 offset:33856
    s_setprio 0
    v_mfma_f32_32x32x16_bf16 v[160:175], v[60:63], v[48:51], v[160:175]
    s_setprio 2
    ds_read_b64_tr_b16 v[40:41], v12 offset:0
    ds_read_b64_tr_b16 v[42:43], v12 offset:512
    ds_read_b64_tr_b16 v[44:45], v12 offset:256
    ds_read_b64_tr_b16 v[46:47], v12 offset:768
    s_setprio 0
    v_mfma_f32_32x32x16_bf16 v[176:191], v[60:63], v[52:55], v[176:191]
    s_setprio 2
    s_waitcnt lgkmcnt(6)
    s_setprio 0
    v_mfma_f32_32x32x16_bf16 v[128:143], v[72:75], v[64:67], v[128:143]
    s_setprio 2
    s_add_u32 m0, s46, 4096
    s_nop 0
    buffer_load_dwordx4 v9, s[32:35], s48 offen lds
    buffer_load_dwordx4 v10, s[32:35], s48 offen offset:1024 lds
    s_add_u32 s48, s48, s49
    s_setprio 0
    v_mfma_f32_32x32x16_bf16 v[144:159], v[72:75], v[68:71], v[144:159]
    s_setprio 2
    s_waitcnt vmcnt(2)
    ds_read_b128 v[48:51], v11 offset:608
    ds_read_b128 v[52:55], v11 offset:33888
    s_setprio 0
    v_mfma_f32_32x32x16_bf16 v[160:175], v[76:79], v[64:67], v[160:175]
    s_setprio 2
    ds_read_b64_tr_b16 v[56:57], v12 offset:2048
    ds_read_b64_tr_b16 v[58:59], v12 offset:2560
    ds_read_b64_tr_b16 v[60:61], v12 offset:2304
    ds_read_b64_tr_b16 v[62:63], v12 offset:2816
    s_setprio 0
    v_mfma_f32_32x32x16_bf16 v[176:191], v[76:79], v[68:71], v[176:191]
    s_setprio 2
    s_waitcnt lgkmcnt(6)
    s_setprio 0
    v_mfma_f32_32x32x16_bf16 v[128:143], v[40:43], v[32:35], v[128:143]
    s_setprio 2
    s_add_u32 m0, s46, 0
    s_nop 0
    buffer_load_dwordx4 v9, s[32:35], s48 offen lds
    buffer_load_dwordx4 v10, s[32:35], s48 offen offset:1024 lds
    s_add_u32 s48, s48, s49
    s_setprio 0
    v_mfma_f32_32x32x16_bf16 v[144:159], v[40:43], v[36:39], v[144:159]
    s_setprio 2
    s_waitcnt vmcnt(2)
    ds_read_b128 v[64:67], v11 offset:640
    ds_read_b128 v[68:71], v11 offset:33920
    s_setprio 0
    v_mfma_f32_32x32x16_bf16 v[160:175], v[44:47], v[32:35], v[160:175]
    s_setprio 2
    ds_read_b64_tr_b16 v[72:73], v12 offset:4096
    ds_read_b64_tr_b16 v[74:75], v12 offset:4608
    ds_read_b64_tr_b16 v[76:77], v12 offset:4352
    ds_read_b64_tr_b16 v[78:79], v12 offset:4864
    s_setprio 0
    v_mfma_f32_32x32x16_bf16 v[176:191], v[44:47], v[36:39], v[176:191]
    s_setprio 2
    s_waitcnt lgkmcnt(6)
    s_setprio 0
    v_mfma_f32_32x32x16_bf16 v[128:143], v[56:59], v[48:51], v[128:143]
    s_setprio 2
    s_add_u32 m0, s46, 2048
    s_nop 0
    buffer_load_dwordx4 v9, s[32:35], s48 offen lds
    buffer_load_dwordx4 v10, s[32:35], s48 offen offset:1024 lds
    s_add_u32 s48, s48, s49
    s_setprio 0
    v_mfma_f32_32x32x16_bf16 v[144:159], v[56:59], v[52:55], v[144:159]
    s_setprio 2
    s_waitcnt vmcnt(2)
    ds_read_b128 v[32:35], v11 offset:672
    ds_read_b128 v[36:39], v11 offset:33952
    s_setprio 0
    v_mfma_f32_32x32x16_bf16 v[160:175], v[60:63], v[48:51], v[160:175]
    s_setprio 2
    ds_read_b64_tr_b16 v[40:41], v12 offset:0
    ds_read_b64_tr_b16 v[42:43], v12 offset:512
    ds_read_b64_tr_b16 v[44:45], v12 offset:256
    ds_read_b64_tr_b16 v[46:47], v12 offset:768
    s_setprio 0
    v_mfma_f32_32x32x16_bf16 v[176:191], v[60:63], v[52:55], v[176:191]
    s_setprio 2
    s_waitcnt lgkmcnt(6)
    s_setprio 0
    v_mfma_f32_32x32x16_bf16 v[128:143], v[72:75], v[64:67], v[128:143]
    s_setprio 2
    s_add_u32 m0, s46, 4096
    s_nop 0
    buffer_load_dwordx4 v9, s[32:35], s48 offen lds
    buffer_load_dwordx4 v10, s[32:35], s48 offen offset:1024 lds
    s_add_u32 s48, s48, s49
    s_setprio 0
    v_mfma_f32_32x32x16_bf16 v[144:159], v[72:75], v[68:71], v[144:159]
    s_setprio 2
    s_waitcnt vmcnt(2)
    ds_read_b128 v[48:51], v11 offset:704
    ds_read_b128 v[52:55], v11 offset:33984
    s_setprio 0
    v_mfma_f32_32x32x16_bf16 v[160:175], v[76:79], v[64:67], v[160:175]
    s_setprio 2
    ds_read_b64_tr_b16 v[56:57], v12 offset:2048
    ds_read_b64_tr_b16 v[58:59], v12 offset:2560
    ds_read_b64_tr_b16 v[60:61], v12 offset:2304
    ds_read_b64_tr_b16 v[62:63], v12 offset:2816
    s_setprio 0
    v_mfma_f32_32x32x16_bf16 v[176:191], v[76:79], v[68:71], v[176:191]
    s_setprio 2
    s_waitcnt lgkmcnt(6)
    s_setprio 0
    v_mfma_f32_32x32x16_bf16 v[128:143], v[40:43], v[32:35], v[128:143]
    s_setprio 2
    s_add_u32 m0, s46, 0
    s_nop 0
    buffer_load_dwordx4 v9, s[32:35], s48 offen lds
    buffer_load_dwordx4 v10, s[32:35], s48 offen offset:1024 lds
    s_add_u32 s48, s48, s49
    s_setprio 0
    v_mfma_f32_32x32x16_bf16 v[144:159], v[40:43], v[36:39], v[144:159]
    s_setprio 2
    s_waitcnt vmcnt(2)
    ds_read_b128 v[64:67], v11 offset:736
    ds_read_b128 v[68:71], v11 offset:34016
    s_setprio 0
    v_mfma_f32_32x32x16_bf16 v[160:175], v[44:47], v[32:35], v[160:175]
    s_setprio 2
    ds_read_b64_tr_b16 v[72:73], v12 offset:4096
    ds_read_b64_tr_b16 v[74:75], v12 offset:4608
    ds_read_b64_tr_b16 v[76:77], v12 offset:4352
    ds_read_b64_tr_b16 v[78:79], v12 offset:4864
    s_setprio 0
    v_mfma_f32_32x32x16_bf16 v[176:191], v[44:47], v[36:39], v[176:191]
    s_setprio 2
    s_waitcnt lgkmcnt(6)
    s_setprio 0
    v_mfma_f32_32x32x16_bf16 v[128:143], v[56:59], v[48:51], v[128:143]
    s_setprio 2
    s_add_u32 m0, s46, 2048
    s_nop 0
    buffer_load_dwordx4 v9, s[32:35], s48 offen lds
    buffer_load_dwordx4 v10, s[32:35], s48 offen offset:1024 lds
    s_add_u32 s48, s48, s49
    s_setprio 0
    v_mfma_f32_32x32x16_bf16 v[144:159], v[56:59], v[52:55], v[144:159]
    s_setprio 2
    s_waitcnt vmcnt(2)
    ds_read_b128 v[32:35], v11 offset:768
    ds_read_b128 v[36:39], v11 offset:34048
    s_setprio 0
    v_mfma_f32_32x32x16_bf16 v[160:175], v[60:63], v[48:51], v[160:175]
    s_setprio 2
    ds_read_b64_tr_b16 v[40:41], v12 offset:0
    ds_read_b64_tr_b16 v[42:43], v12 offset:512
    ds_read_b64_tr_b16 v[44:45], v12 offset:256
    ds_read_b64_tr_b16 v[46:47], v12 offset:768
    s_setprio 0
    v_mfma_f32_32x32x16_bf16 v[176:191], v[60:63], v[52:55], v[176:191]
    s_setprio 2
    s_waitcnt lgkmcnt(6)
    s_setprio 0
    v_mfma_f32_32x32x16_bf16 v[128:143], v[72:75], v[64:67], v[128:143]
    s_setprio 2
    s_add_u32 m0, s46, 4096
    s_nop 0
    buffer_load_dwordx4 v9, s[32:35], s48 offen lds
    buffer_load_dwordx4 v10, s[32:35], s48 offen offset:1024 lds
    s_add_u32 s48, s48, s49
    s_setprio 0
    v_mfma_f32_32x32x16_bf16 v[144:159], v[72:75], v[68:71], v[144:159]
    s_setprio 2
    s_waitcnt vmcnt(2)
    ds_read_b128 v[48:51], v11 offset:800
    ds_read_b128 v[52:55], v11 offset:34080
    s_setprio 0
    v_mfma_f32_32x32x16_bf16 v[160:175], v[76:79], v[64:67], v[160:175]
    s_setprio 2
    ds_read_b64_tr_b16 v[56:57], v12 offset:2048
    ds_read_b64_tr_b16 v[58:59], v12 offset:2560
    ds_read_b64_tr_b16 v[60:61], v12 offset:2304
    ds_read_b64_tr_b16 v[62:63], v12 offset:2816
    s_setprio 0
    v_mfma_f32_32x32x16_bf16 v[176:191], v[76:79], v[68:71], v[176:191]
    s_setprio 2
    s_waitcnt lgkmcnt(6)
    s_setprio 0
    v_mfma_f32_32x32x16_bf16 v[128:143], v[40:43], v[32:35], v[128:143]
    s_setprio 2
    s_add_u32 m0, s46, 0
    s_nop 0
    buffer_load_dwordx4 v9, s[32:35], s48 offen lds
    buffer_load_dwordx4 v10, s[32:35], s48 offen offset:1024 lds
    s_add_u32 s48, s48, s49
    s_setprio 0
    v_mfma_f32_32x32x16_bf16 v[144:159], v[40:43], v[36:39], v[144:159]
    s_setprio 2
    s_waitcnt vmcnt(2)
    ds_read_b128 v[64:67], v11 offset:832
    ds_read_b128 v[68:71], v11 offset:34112
    s_setprio 0
    v_mfma_f32_32x32x16_bf16 v[160:175], v[44:47], v[32:35], v[160:175]
    s_setprio 2
    ds_read_b64_tr_b16 v[72:73], v12 offset:4096
    ds_read_b64_tr_b16 v[74:75], v12 offset:4608
    ds_read_b64_tr_b16 v[76:77], v12 offset:4352
    ds_read_b64_tr_b16 v[78:79], v12 offset:4864
    s_setprio 0
    v_mfma_f32_32x32x16_bf16 v[176:191], v[44:47], v[36:39], v[176:191]
    s_setprio 2
    s_waitcnt lgkmcnt(6)
    s_setprio 0
    v_mfma_f32_32x32x16_bf16 v[128:143], v[56:59], v[48:51], v[128:143]
    s_setprio 2
    s_add_u32 m0, s46, 2048
    s_nop 0
    buffer_load_dwordx4 v9, s[32:35], s48 offen lds
    buffer_load_dwordx4 v10, s[32:35], s48 offen offset:1024 lds
    s_add_u32 s48, s48, s49
    s_setprio 0
    v_mfma_f32_32x32x16_bf16 v[144:159], v[56:59], v[52:55], v[144:159]
    s_setprio 2
    s_waitcnt vmcnt(2)
    ds_read_b128 v[32:35], v11 offset:864
    ds_read_b128 v[36:39], v11 offset:34144
    s_setprio 0
    v_mfma_f32_32x32x16_bf16 v[160:175], v[60:63], v[48:51], v[160:175]
    s_setprio 2
    ds_read_b64_tr_b16 v[40:41], v12 offset:0
    ds_read_b64_tr_b16 v[42:43], v12 offset:512
    ds_read_b64_tr_b16 v[44:45], v12 offset:256
    ds_read_b64_tr_b16 v[46:47], v12 offset:768
    s_setprio 0
    v_mfma_f32_32x32x16_bf16 v[176:191], v[60:63], v[52:55], v[176:191]
    s_setprio 2
    s_waitcnt lgkmcnt(6)
    s_setprio 0
    v_mfma_f32_32x32x16_bf16 v[128:143], v[72:75], v[64:67], v[128:143]
    s_setprio 2
    s_add_u32 m0, s46, 4096
    s_nop 0
    buffer_load_dwordx4 v9, s[32:35], s48 offen lds
    buffer_load_dwordx4 v10, s[32:35], s48 offen offset:1024 lds
    s_add_u32 s48, s48, s49
    s_setprio 0
    v_mfma_f32_32x32x16_bf16 v[144:159], v[72:75], v[68:71], v[144:159]
    s_setprio 2
    s_waitcnt vmcnt(2)
    ds_read_b128 v[48:51], v11 offset:896
    ds_read_b128 v[52:55], v11 offset:34176
    s_setprio 0
    v_mfma_f32_32x32x16_bf16 v[160:175], v[76:79], v[64:67], v[160:175]
    s_setprio 2
    ds_read_b64_tr_b16 v[56:57], v12 offset:2048
    ds_read_b64_tr_b16 v[58:59], v12 offset:2560
    ds_read_b64_tr_b16 v[60:61], v12 offset:2304
    ds_read_b64_tr_b16 v[62:63], v12 offset:2816
    s_setprio 0
    v_mfma_f32_32x32x16_bf16 v[176:191], v[76:79], v[68:71], v[176:191]
    s_setprio 2
    s_waitcnt lgkmcnt(6)
    s_setprio 0
    v_mfma_f32_32x32x16_bf16 v[128:143], v[40:43], v[32:35], v[128:143]
    s_setprio 2
    s_add_u32 m0, s46, 0
    s_nop 0
    buffer_load_dwordx4 v9, s[32:35], s48 offen lds
    buffer_load_dwordx4 v10, s[32:35], s48 offen offset:1024 lds
    s_add_u32 s48, s48, s49
    s_setprio 0
    v_mfma_f32_32x32x16_bf16 v[144:159], v[40:43], v[36:39], v[144:159]
    s_setprio 2
    s_waitcnt vmcnt(2)
    ds_read_b128 v[64:67], v11 offset:928
    ds_read_b128 v[68:71], v11 offset:34208
    s_setprio 0
    v_mfma_f32_32x32x16_bf16 v[160:175], v[44:47], v[32:35], v[160:175]
    s_setprio 2
    ds_read_b64_tr_b16 v[72:73], v12 offset:4096
    ds_read_b64_tr_b16 v[74:75], v12 offset:4608
    ds_read_b64_tr_b16 v[76:77], v12 offset:4352
    ds_read_b64_tr_b16 v[78:79], v12 offset:4864
    s_setprio 0
    v_mfma_f32_32x32x16_bf16 v[176:191], v[44:47], v[36:39], v[176:191]
    s_setprio 2
    s_waitcnt lgkmcnt(6)
    s_setprio 0
    v_mfma_f32_32x32x16_bf16 v[128:143], v[56:59], v[48:51], v[128:143]
    s_setprio 2
    s_add_u32 m0, s46, 2048
    s_nop 0
    buffer_load_dwordx4 v9, s[32:35], s48 offen lds
    buffer_load_dwordx4 v10, s[32:35], s48 offen offset:1024 lds
    s_add_u32 s48, s48, s49
    s_setprio 0
    v_mfma_f32_32x32x16_bf16 v[144:159], v[56:59], v[52:55], v[144:159]
    s_setprio 2
    s_waitcnt vmcnt(2)
    ds_read_b128 v[32:35], v11 offset:960
    ds_read_b128 v[36:39], v11 offset:34240
    s_setprio 0
    v_mfma_f32_32x32x16_bf16 v[160:175], v[60:63], v[48:51], v[160:175]
    s_setprio 2
    ds_read_b64_tr_b16 v[40:41], v12 offset:0
    ds_read_b64_tr_b16 v[42:43], v12 offset:512
    ds_read_b64_tr_b16 v[44:45], v12 offset:256
    ds_read_b64_tr_b16 v[46:47], v12 offset:768
    s_setprio 0
    v_mfma_f32_32x32x16_bf16 v[176:191], v[60:63], v[52:55], v[176:191]
    s_setprio 2
    s_waitcnt lgkmcnt(6)
    s_setprio 0
    v_mfma_f32_32x32x16_bf16 v[128:143], v[72:75], v[64:67], v[128:143]
    s_setprio 2
    s_setprio 0
    v_mfma_f32_32x32x16_bf16 v[144:159], v[72:75], v[68:71], v[144:159]
    s_setprio 2
    s_waitcnt vmcnt(0)
    ds_read_b128 v[48:51], v11 offset:992
    ds_read_b128 v[52:55], v11 offset:34272
    s_setprio 0
    v_mfma_f32_32x32x16_bf16 v[160:175], v[76:79], v[64:67], v[160:175]
    s_setprio 2
    ds_read_b64_tr_b16 v[56:57], v12 offset:2048
    ds_read_b64_tr_b16 v[58:59], v12 offset:2560
    ds_read_b64_tr_b16 v[60:61], v12 offset:2304
    ds_read_b64_tr_b16 v[62:63], v12 offset:2816
    s_setprio 0
    v_mfma_f32_32x32x16_bf16 v[176:191], v[76:79], v[68:71], v[176:191]
    s_setprio 2
    s_waitcnt lgkmcnt(6)
    s_setprio 0
    v_mfma_f32_32x32x16_bf16 v[128:143], v[40:43], v[32:35], v[128:143]
    s_setprio 2
    s_setprio 0
    v_mfma_f32_32x32x16_bf16 v[144:159], v[40:43], v[36:39], v[144:159]
    s_setprio 2
    s_setprio 0
    v_mfma_f32_32x32x16_bf16 v[160:175], v[44:47], v[32:35], v[160:175]
    s_setprio 2
    s_setprio 0
    v_mfma_f32_32x32x16_bf16 v[176:191], v[44:47], v[36:39], v[176:191]
    s_setprio 2
    s_waitcnt lgkmcnt(0)
    s_mov_b64 exec, 1
    ds_add_u32 v2, v3 offset:32
    s_mov_b64 exec, -1
    s_lshl_b32 s50, s56, 10
    s_add_u32 s50, s50, 266240
    s_buffer_load_dword s24, s[12:15], s50 offset:0
    s_buffer_load_dword s25, s[12:15], s50 offset:128
    s_buffer_load_dword s26, s[12:15], s50 offset:256
    s_buffer_load_dword s27, s[12:15], s50 offset:384
    s_buffer_load_dword s28, s[12:15], s50 offset:512
    s_buffer_load_dword s29, s[12:15], s50 offset:640
    s_buffer_load_dword s30, s[12:15], s50 offset:768
    s_buffer_load_dword s31, s[12:15], s50 offset:896
    s_add_u32 s50, s50, 8192
    s_setprio 0
    v_mfma_f32_32x32x16_bf16 v[128:143], v[56:59], v[48:51], v[128:143]
    s_setprio 2
    s_setprio 0
    v_mfma_f32_32x32x16_bf16 v[144:159], v[56:59], v[52:55], v[144:159]
    s_setprio 2
    s_setprio 0
    v_mfma_f32_32x32x16_bf16 v[160:175], v[60:63], v[48:51], v[160:175]
    s_setprio 2
    s_setprio 0
    v_mfma_f32_32x32x16_bf16 v[176:191], v[60:63], v[52:55], v[176:191]
    s_setprio 2
    s_nop 9
    v_cvt_pk_bf16_f32 v64, v128, v129
    v_cvt_pk_bf16_f32 v65, v130, v131
    v_cvt_pk_bf16_f32 v66, v132, v133
    v_cvt_pk_bf16_f32 v67, v134, v135
    v_cvt_pk_bf16_f32 v68, v136, v137
    v_cvt_pk_bf16_f32 v69, v138, v139
    v_cvt_pk_bf16_f32 v70, v140, v141
    v_cvt_pk_bf16_f32 v71, v142, v143
    v_pk_max_i16 v64, v64, 0
    v_pk_max_i16 v65, v65, 0
    v_pk_max_i16 v66, v66, 0
    v_pk_max_i16 v67, v67, 0
    v_pk_max_i16 v68, v68, 0
    v_pk_max_i16 v69, v69, 0
    v_pk_max_i16 v70, v70, 0
    v_pk_max_i16 v71, v71, 0
    v_cvt_pk_bf16_f32 v72, v144, v145
    v_cvt_pk_bf16_f32 v73, v146, v147
    v_cvt_pk_bf16_f32 v74, v148, v149
    v_cvt_pk_bf16_f32 v75, v150, v151
    v_cvt_pk_bf16_f32 v76, v152, v153
    v_cvt_pk_bf16_f32 v77, v154, v155
    v_cvt_pk_bf16_f32 v78, v156, v157
    v_cvt_pk_bf16_f32 v79, v158, v159
    v_pk_max_i16 v72, v72, 0
    v_pk_max_i16 v73, v73, 0
    v_pk_max_i16 v74, v74, 0
    v_pk_max_i16 v75, v75, 0
    v_pk_max_i16 v76, v76, 0
    v_pk_max_i16 v77, v77, 0
    v_pk_max_i16 v78, v78, 0
    v_pk_max_i16 v79, v79, 0
    v_cvt_pk_bf16_f32 v80, v160, v161
    v_cvt_pk_bf16_f32 v81, v162, v163
    v_cvt_pk_bf16_f32 v82, v164, v165
    v_cvt_pk_bf16_f32 v83, v166, v167
    v_cvt_pk_bf16_f32 v84, v168, v169
    v_cvt_pk_bf16_f32 v85, v170, v171
    v_cvt_pk_bf16_f32 v86, v172, v173
    v_cvt_pk_bf16_f32 v87, v174, v175
    v_pk_max_i16 v80, v80, 0
    v_pk_max_i16 v81, v81, 0
    v_pk_max_i16 v82, v82, 0
    v_pk_max_i16 v83, v83, 0
    v_pk_max_i16 v84, v84, 0
    v_pk_max_i16 v85, v85, 0
    v_pk_max_i16 v86, v86, 0
    v_pk_max_i16 v87, v87, 0
    v_cvt_pk_bf16_f32 v88, v176, v177
    v_cvt_pk_bf16_f32 v89, v178, v179
    v_cvt_pk_bf16_f32 v90, v180, v181
    v_cvt_pk_bf16_f32 v91, v182, v183
    v_cvt_pk_bf16_f32 v92, v184, v185
    v_cvt_pk_bf16_f32 v93, v186, v187
    v_cvt_pk_bf16_f32 v94, v188, v189
    v_cvt_pk_bf16_f32 v95, v190, v191
    v_pk_max_i16 v88, v88, 0
    v_pk_max_i16 v89, v89, 0
    v_pk_max_i16 v90, v90, 0
    v_pk_max_i16 v91, v91, 0
    v_pk_max_i16 v92, v92, 0
    v_pk_max_i16 v93, v93, 0
    v_pk_max_i16 v94, v94, 0
    v_pk_max_i16 v95, v95, 0
    s_branch L_G1_DONE
L_G1_N:
    v_lshl_add_u32 v12, v24, 9, v23
    v_add_u32 v12, s46, v12
    s_waitcnt vmcnt(5)
    ds_read_b128 v[32:35], v11 offset:0
    ds_read_b128 v[36:39], v11 offset:33280
    ds_read_b64_tr_b16 v[40:41], v12 offset:0
    ds_read_b64_tr_b16 v[42:43], v12 offset:256
    s_waitcnt lgkmcnt(10)
    ds_read_b128 v[44:47], v11 offset:32
    ds_read_b128 v[48:51], v11 offset:33312
    ds_read_b64_tr_b16 v[52:53], v12 offset:1024
    ds_read_b64_tr_b16 v[54:55], v12 offset:1280
    s_waitcnt vmcnt(3)
    ds_read_b128 v[56:59], v11 offset:64
    ds_read_b128 v[60:63], v11 offset:33344
    ds_read_b64_tr_b16 v[64:65], v12 offset:2048
    ds_read_b64_tr_b16 v[66:67], v12 offset:2304
    s_waitcnt lgkmcnt(10)
    ds_read_b128 v[68:71], v11 offset:96
    ds_read_b128 v[72:75], v11 offset:33376
    ds_read_b64_tr_b16 v[76:77], v12 offset:3072
    ds_read_b64_tr_b16 v[78:79], v12 offset:3328
    s_waitcnt lgkmcnt(8)
    s_setprio 0
    v_mfma_f32_32x32x16_bf16 v[128:143], v[40:43], v[32:35], 0
    s_setprio 2
    s_add_u32 m0, s46, 0
    s_nop 0
    buffer_load_dwordx4 v9, s[32:35], s48 offen lds
    buffer_load_dwordx4 v10, s[32:35], s48 offen offset:1024 lds
    s_add_u32 s48, s48, s49
    s_setprio 0
    v_mfma_f32_32x32x16_bf16 v[144:159], v[40:43], v[36:39], 0
    s_setprio 2
    s_waitcnt vmcnt(3)
    ds_read_b128 v[80:83], v11 offset:128
    ds_read_b128 v[84:87], v11 offset:33408
    ds_read_b64_tr_b16 v[88:89], v12 offset:4096
    ds_read_b64_tr_b16 v[90:91], v12 offset:4352
    s_setprio 0
    v_mfma_f32_32x32x16_bf16 v[128:143], v[52:55], v[44:47], v[128:143]
    s_setprio 2
    s_waitcnt lgkmcnt(10)
    ds_read_b128 v[92:95], v11 offset:160
    ds_read_b128 v[96:99], v11 offset:33440
    ds_read_b64_tr_b16 v[100:101], v12 offset:5120
    ds_read_b64_tr_b16 v[102:103], v12 offset:5376
    s_setprio 0
    v_mfma_f32_32x32x16_bf16 v[144:159], v[52:55], v[48:51], v[144:159]
    s_setprio 2
    s_waitcnt lgkmcnt(8)
    s_setprio 0
    v_mfma_f32_32x32x16_bf16 v[128:143], v[64:67], v[56:59], v[128:143]
    s_setprio 2
    s_add_u32 m0, s46, 2048
    s_nop 0
    buffer_load_dwordx4 v9, s[32:35], s48 offen lds
    buffer_load_dwordx4 v10, s[32:35], s48 offen offset:1024 lds
    s_add_u32 s48, s48, s49
    s_setprio 0
    v_mfma_f32_32x32x16_bf16 v[144:159], v[64:67], v[60:63], v[144:159]
    s_setprio 2
    s_waitcnt vmcnt(2)
    ds_read_b128 v[32:35], v11 offset:192
    ds_read_b128 v[36:39], v11 offset:33472
    ds_read_b64_tr_b16 v[40:41], v12 offset:0
    ds_read_b64_tr_b16 v[42:43], v12 offset:256
    s_setprio 0
    v_mfma_f32_32x32x16_bf16 v[128:143], v[76:79], v[68:71], v[128:143]
    s_setprio 2
    s_waitcnt lgkmcnt(10)
    ds_read_b128 v[44:47], v11 offset:224
    ds_read_b128 v[48:51], v11 offset:33504
    ds_read_b64_tr_b16 v[52:53], v12 offset:1024
    ds_read_b64_tr_b16 v[54:55], v12 offset:1280
    s_setprio 0
    v_mfma_f32_32x32x16_bf16 v[144:159], v[76:79], v[72:75], v[144:159]
    s_setprio 2
    s_waitcnt lgkmcnt(8)
    s_setprio 0
    v_mfma_f32_32x32x16_bf16 v[128:143], v[88:91], v[80:83], v[128:143]
    s_setprio 2
    s_add_u32 m0, s46, 4096
    s_nop 0
    buffer_load_dwordx4 v9, s[32:35], s48 offen lds
    buffer_load_dwordx4 v10, s[32:35], s48 offen offset:1024 lds
    s_add_u32 s48, s48, s49
    s_setprio 0
    v_mfma_f32_32x32x16_bf16 v[144:159], v[88:91], v[84:87], v[144:159]
    s_setprio 2
    s_waitcnt vmcnt(2)
    ds_read_b128 v[56:59], v11 offset:256
    ds_read_b128 v[60:63], v11 offset:33536
    ds_read_b64_tr_b16 v[64:65], v12 offset:2048
    ds_read_b64_tr_b16 v[66:67], v12 offset:2304
    s_setprio 0
    v_mfma_f32_32x32x16_bf16 v[128:143], v[100:103], v[92:95], v[128:143]
    s_setprio 2
    s_waitcnt lgkmcnt(10)
    ds_read_b128 v[68:71], v11 offset:288
    ds_read_b128 v[72:75], v11 offset:33568
    ds_read_b64_tr_b16 v[76:77], v12 offset:3072
    ds_read_b64_tr_b16 v[78:79], v12 offset:3328
    s_setprio 0
    v_mfma_f32_32x32x16_bf16 v[144:159], v[100:103], v[96:99], v[144:159]
    s_setprio 2
    s_waitcnt lgkmcnt(8)
    s_setprio 0
    v_mfma_f32_32x32x16_bf16 v[128:143], v[40:43], v[32:35], v[128:143]
    s_setprio 2
    s_add_u32 m0, s46, 0
    s_nop 0
    buffer_load_dwordx4 v9, s[32:35], s48 offen lds
    buffer_load_dwordx4 v10, s[32:35], s48 offen offset:1024 lds
    s_add_u32 s48, s48, s49
    s_setprio 0
    v_mfma_f32_32x32x16_bf16 v[144:159], v[40:43], v[36:39], v[144:159]
    s_setprio 2
    s_waitcnt vmcnt(2)
    ds_read_b128 v[80:83], v11 offset:320
    ds_read_b128 v[84:87], v11 offset:33600
    ds_read_b64_tr_b16 v[88:89], v12 offset:4096
    ds_read_b64_tr_b16 v[90:91], v12 offset:4352
    s_setprio 0
    v_mfma_f32_32x32x16_bf16 v[128:143], v[52:55], v[44:47], v[128:143]
    s_setprio 2
    s_waitcnt lgkmcnt(10)
    ds_read_b128 v[92:95], v11 offset:352
    ds_read_b128 v[96:99], v11 offset:33632
    ds_read_b64_tr_b16 v[100:101], v12 offset:5120
    ds_read_b64_tr_b16 v[102:103], v12 offset:5376
    s_setprio 0
    v_mfma_f32_32x32x16_bf16 v[144:159], v[52:55], v[48:51], v[144:159]
    s_setprio 2
    s_waitcnt lgkmcnt(8)
    s_setprio 0
    v_mfma_f32_32x32x16_bf16 v[128:143], v[64:67], v[56:59], v[128:143]
    s_setprio 2
    s_add_u32 m0, s46, 2048
    s_nop 0
    buffer_load_dwordx4 v9, s[32:35], s48 offen lds
    buffer_load_dwordx4 v10, s[32:35], s48 offen offset:1024 lds
    s_add_u32 s48, s48, s49
    s_setprio 0
    v_mfma_f32_32x32x16_bf16 v[144:159], v[64:67], v[60:63], v[144:159]
    s_setprio 2
    s_waitcnt vmcnt(2)
    ds_read_b128 v[32:35], v11 offset:384
    ds_read_b128 v[36:39], v11 offset:33664
    ds_read_b64_tr_b16 v[40:41], v12 offset:0
    ds_read_b64_tr_b16 v[42:43], v12 offset:256
    s_setprio 0
    v_mfma_f32_32x32x16_bf16 v[128:143], v[76:79], v[68:71], v[128:143]
    s_setprio 2
    s_waitcnt lgkmcnt(10)
    ds_read_b128 v[44:47], v11 offset:416
    ds_read_b128 v[48:51], v11 offset:33696
    ds_read_b64_tr_b16 v[52:53], v12 offset:1024
    ds_read_b64_tr_b16 v[54:55], v12 offset:1280
    s_setprio 0
    v_mfma_f32_32x32x16_bf16 v[144:159], v[76:79], v[72:75], v[144:159]
    s_setprio 2
    s_waitcnt lgkmcnt(8)
    s_setprio 0
    v_mfma_f32_32x32x16_bf16 v[128:143], v[88:91], v[80:83], v[128:143]
    s_setprio 2
    s_add_u32 m0, s46, 4096
    s_nop 0
    buffer_load_dwordx4 v9, s[32:35], s48 offen lds
    buffer_load_dwordx4 v10, s[32:35], s48 offen offset:1024 lds
    s_add_u32 s48, s48, s49
    s_setprio 0
    v_mfma_f32_32x32x16_bf16 v[144:159], v[88:91], v[84:87], v[144:159]
    s_setprio 2
    s_waitcnt vmcnt(2)
    ds_read_b128 v[56:59], v11 offset:448
    ds_read_b128 v[60:63], v11 offset:33728
    ds_read_b64_tr_b16 v[64:65], v12 offset:2048
    ds_read_b64_tr_b16 v[66:67], v12 offset:2304
    s_setprio 0
    v_mfma_f32_32x32x16_bf16 v[128:143], v[100:103], v[92:95], v[128:143]
    s_setprio 2
    s_waitcnt lgkmcnt(10)
    ds_read_b128 v[68:71], v11 offset:480
    ds_read_b128 v[72:75], v11 offset:33760
    ds_read_b64_tr_b16 v[76:77], v12 offset:3072
    ds_read_b64_tr_b16 v[78:79], v12 offset:3328
    s_setprio 0
    v_mfma_f32_32x32x16_bf16 v[144:159], v[100:103], v[96:99], v[144:159]
    s_setprio 2
    s_waitcnt lgkmcnt(8)
    s_setprio 0
    v_mfma_f32_32x32x16_bf16 v[128:143], v[40:43], v[32:35], v[128:143]
    s_setprio 2
    s_add_u32 m0, s46, 0
    s_nop 0
    buffer_load_dwordx4 v9, s[32:35], s48 offen lds
    buffer_load_dwordx4 v10, s[32:35], s48 offen offset:1024 lds
    s_add_u32 s48, s48, s49
    s_setprio 0
    v_mfma_f32_32x32x16_bf16 v[144:159], v[40:43], v[36:39], v[144:159]
    s_setprio 2
    s_waitcnt vmcnt(2)
    ds_read_b128 v[80:83], v11 offset:512
    ds_read_b128 v[84:87], v11 offset:33792
    ds_read_b64_tr_b16 v[88:89], v12 offset:4096
    ds_read_b64_tr_b16 v[90:91], v12 offset:4352
    s_setprio 0
    v_mfma_f32_32x32x16_bf16 v[128:143], v[52:55], v[44:47], v[128:143]
    s_setprio 2
    s_waitcnt lgkmcnt(10)
    ds_read_b128 v[92:95], v11 offset:544
    ds_read_b128 v[96:99], v11 offset:33824
    ds_read_b64_tr_b16 v[100:101], v12 offset:5120
    ds_read_b64_tr_b16 v[102:103], v12 offset:5376
    s_setprio 0
    v_mfma_f32_32x32x16_bf16 v[144:159], v[52:55], v[48:51], v[144:159]
    s_setprio 2
    s_waitcnt lgkmcnt(8)
    s_setprio 0
    v_mfma_f32_32x32x16_bf16 v[128:143], v[64:67], v[56:59], v[128:143]
    s_setprio 2
    s_add_u32 m0, s46, 2048
    s_nop 0
    buffer_load_dwordx4 v9, s[32:35], s48 offen lds
    buffer_load_dwordx4 v10, s[32:35], s48 offen offset:1024 lds
    s_add_u32 s48, s48, s49
    s_setprio 0
    v_mfma_f32_32x32x16_bf16 v[144:159], v[64:67], v[60:63], v[144:159]
    s_setprio 2
    s_waitcnt vmcnt(2)
    ds_read_b128 v[32:35], v11 offset:576
    ds_read_b128 v[36:39], v11 offset:33856
    ds_read_b64_tr_b16 v[40:41], v12 offset:0
    ds_read_b64_tr_b16 v[42:43], v12 offset:256
    s_setprio 0
    v_mfma_f32_32x32x16_bf16 v[128:143], v[76:79], v[68:71], v[128:143]
    s_setprio 2
    s_waitcnt lgkmcnt(10)
    ds_read_b128 v[44:47], v11 offset:608
    ds_read_b128 v[48:51], v11 offset:33888
    ds_read_b64_tr_b16 v[52:53], v12 offset:1024
    ds_read_b64_tr_b16 v[54:55], v12 offset:1280
    s_setprio 0
    v_mfma_f32_32x32x16_bf16 v[144:159], v[76:79], v[72:75], v[144:159]
    s_setprio 2
    s_waitcnt lgkmcnt(8)
    s_setprio 0
    v_mfma_f32_32x32x16_bf16 v[128:143], v[88:91], v[80:83], v[128:143]
    s_setprio 2
    s_mov_b32 s47, 32768
WC_12:
    ds_read_b32 v4, v2 offset:28
    s_waitcnt lgkmcnt(0)
    v_readfirstlane_b32 s43, v4
    s_sub_u32 s47, s47, 1
    s_cbranch_scc1 WD_13
    s_cmp_ge_u32 s43, 4
    s_cbranch_scc1 WD_13
    s_sleep 1
    s_branch WC_12
WD_13:
    s_mov_b32 s50, s48
    s_lshl_b32 s43, s56, 12
    s_add_u32 s48, s43, 33792
    s_add_u32 m0, s43, 33792
    s_nop 0
    buffer_load_dwordx4 v8, s[12:15], s48 offen offset:0 sc1 lds
    buffer_load_dwordx4 v8, s[12:15], s48 offen offset:1024 sc1 lds
    buffer_load_dwordx4 v8, s[12:15], s48 offen offset:2048 sc1 lds
    buffer_load_dwordx4 v8, s[12:15], s48 offen offset:3072 sc1 lds
    s_add_u32 s48, s48, 16384
    s_add_u32 m0, m0, 16384
    s_nop 0
    buffer_load_dwordx4 v8, s[12:15], s48 offen offset:0 sc1 lds
    buffer_load_dwordx4 v8, s[12:15], s48 offen offset:1024 sc1 lds
    buffer_load_dwordx4 v8, s[12:15], s48 offen offset:2048 sc1 lds
    buffer_load_dwordx4 v8, s[12:15], s48 offen offset:3072 sc1 lds
    s_add_u32 s48, s48, 16384
    s_add_u32 m0, m0, 16384
    s_cmp_lg_u32 s56, 0
    s_cbranch_scc1 KD_14
    buffer_load_dwordx4 v8, s[12:15], s48 offen sc1 lds
KD_14:
    s_mov_b32 s48, s50
    v_mov_b64 v[120:121], -1
    v_mov_b64 v[122:123], -1
    s_lshl_b32 s43, s42, 13
    s_lshr_b32 s60, s56, 1
    s_lshl_b32 s60, s60, 12
    s_add_u32 s43, s43, s60
    s_and_b32 s60, s56, 1
    s_lshl_b32 s60, s60, 10
    s_add_u32 s43, s43, s60
    s_add_u32 s43, s43, s51
    s_add_u32 s43, s43, 229376
    buffer_store_dwordx4 v[120:123], v8, s[12:15], s43 offen sc1
    buffer_store_dwordx4 v[120:123], v8, s[12:15], s43 offen offset:2048 sc1
    s_add_u32 m0, s46, 4096
    s_nop 0
    buffer_load_dwordx4 v9, s[32:35], s48 offen lds
    buffer_load_dwordx4 v10, s[32:35], s48 offen offset:1024 lds
    s_add_u32 s48, s48, s49
    s_setprio 0
    v_mfma_f32_32x32x16_bf16 v[144:159], v[88:91], v[84:87], v[144:159]
    s_setprio 2
    s_waitcnt vmcnt(12)
    ds_read_b128 v[56:59], v11 offset:640
    ds_read_b128 v[60:63], v11 offset:33920
    ds_read_b64_tr_b16 v[64:65], v12 offset:2048
    ds_read_b64_tr_b16 v[66:67], v12 offset:2304
    s_setprio 0
    v_mfma_f32_32x32x16_bf16 v[128:143], v[100:103], v[92:95], v[128:143]
    s_setprio 2
    s_waitcnt lgkmcnt(10)
    ds_read_b128 v[68:71], v11 offset:672
    ds_read_b128 v[72:75], v11 offset:33952
    ds_read_b64_tr_b16 v[76:77], v12 offset:3072
    ds_read_b64_tr_b16 v[78:79], v12 offset:3328
    s_setprio 0
    v_mfma_f32_32x32x16_bf16 v[144:159], v[100:103], v[96:99], v[144:159]
    s_setprio 2
    s_waitcnt lgkmcnt(8)
    s_setprio 0
    v_mfma_f32_32x32x16_bf16 v[128:143], v[40:43], v[32:35], v[128:143]
    s_setprio 2
    s_add_u32 m0, s46, 0
    s_nop 0
    buffer_load_dwordx4 v9, s[32:35], s48 offen lds
    buffer_load_dwordx4 v10, s[32:35], s48 offen offset:1024 lds
    s_add_u32 s48, s48, s49
    s_setprio 0
    v_mfma_f32_32x32x16_bf16 v[144:159], v[40:43], v[36:39], v[144:159]
    s_setprio 2
    s_waitcnt vmcnt(2)
    s_mov_b64 exec, 1
    ds_add_u32 v2, v3 offset:0
    s_mov_b64 exec, -1
    ds_read_b128 v[80:83], v11 offset:704
    ds_read_b128 v[84:87], v11 offset:33984
    ds_read_b64_tr_b16 v[88:89], v12 offset:4096
    ds_read_b64_tr_b16 v[90:91], v12 offset:4352
    s_setprio 0
    v_mfma_f32_32x32x16_bf16 v[128:143], v[52:55], v[44:47], v[128:143]
    s_setprio 2
    s_waitcnt lgkmcnt(10)
    ds_read_b128 v[92:95], v11 offset:736
    ds_read_b128 v[96:99], v11 offset:34016
    ds_read_b64_tr_b16 v[100:101], v12 offset:5120
    ds_read_b64_tr_b16 v[102:103], v12 offset:5376
    s_setprio 0
    v_mfma_f32_32x32x16_bf16 v[144:159], v[52:55], v[48:51], v[144:159]
    s_setprio 2
    s_waitcnt lgkmcnt(8)
    s_setprio 0
    v_mfma_f32_32x32x16_bf16 v[128:143], v[64:67], v[56:59], v[128:143]
    s_setprio 2
    s_add_u32 m0, s46, 2048
    s_nop 0
    buffer_load_dwordx4 v9, s[32:35], s48 offen lds
    buffer_load_dwordx4 v10, s[32:35], s48 offen offset:1024 lds
    s_add_u32 s48, s48, s49
    s_setprio 0
    v_mfma_f32_32x32x16_bf16 v[144:159], v[64:67], v[60:63], v[144:159]
    s_setprio 2
    s_waitcnt vmcnt(2)
    ds_read_b128 v[32:35], v11 offset:768
    ds_read_b128 v[36:39], v11 offset:34048
    ds_read_b64_tr_b16 v[40:41], v12 offset:0
    ds_read_b64_tr_b16 v[42:43], v12 offset:256
    s_setprio 0
    v_mfma_f32_32x32x16_bf16 v[128:143], v[76:79], v[68:71], v[128:143]
    s_setprio 2
    s_waitcnt lgkmcnt(10)
    ds_read_b128 v[44:47], v11 offset:800
    ds_read_b128 v[48:51], v11 offset:34080
    ds_read_b64_tr_b16 v[52:53], v12 offset:1024
    ds_read_b64_tr_b16 v[54:55], v12 offset:1280
    s_setprio 0
    v_mfma_f32_32x32x16_bf16 v[144:159], v[76:79], v[72:75], v[144:159]
    s_setprio 2
    s_waitcnt lgkmcnt(8)
    s_setprio 0
    v_mfma_f32_32x32x16_bf16 v[128:143], v[88:91], v[80:83], v[128:143]
    s_setprio 2
    s_add_u32 m0, s46, 4096
    s_nop 0
    buffer_load_dwordx4 v9, s[32:35], s48 offen lds
    buffer_load_dwordx4 v10, s[32:35], s48 offen offset:1024 lds
    s_add_u32 s48, s48, s49
    s_setprio 0
    v_mfma_f32_32x32x16_bf16 v[144:159], v[88:91], v[84:87], v[144:159]
    s_setprio 2
    s_waitcnt vmcnt(2)
    ds_read_b128 v[56:59], v11 offset:832
    ds_read_b128 v[60:63], v11 offset:34112
    ds_read_b64_tr_b16 v[64:65], v12 offset:2048
    ds_read_b64_tr_b16 v[66:67], v12 offset:2304
    s_setprio 0
    v_mfma_f32_32x32x16_bf16 v[128:143], v[100:103], v[92:95], v[128:143]
    s_setprio 2
    s_waitcnt lgkmcnt(10)
    ds_read_b128 v[68:71], v11 offset:864
    ds_read_b128 v[72:75], v11 offset:34144
    ds_read_b64_tr_b16 v[76:77], v12 offset:3072
    ds_read_b64_tr_b16 v[78:79], v12 offset:3328
    s_setprio 0
    v_mfma_f32_32x32x16_bf16 v[144:159], v[100:103], v[96:99], v[144:159]
    s_setprio 2
    s_waitcnt lgkmcnt(8)
    s_setprio 0
    v_mfma_f32_32x32x16_bf16 v[128:143], v[40:43], v[32:35], v[128:143]
    s_setprio 2
    s_add_u32 m0, s46, 0
    s_nop 0
    buffer_load_dwordx4 v9, s[32:35], s48 offen lds
    buffer_load_dwordx4 v10, s[32:35], s48 offen offset:1024 lds
    s_add_u32 s48, s48, s49
    s_setprio 0
    v_mfma_f32_32x32x16_bf16 v[144:159], v[40:43], v[36:39], v[144:159]
    s_setprio 2
    s_waitcnt vmcnt(2)
    ds_read_b128 v[80:83], v11 offset:896
    ds_read_b128 v[84:87], v11 offset:34176
    ds_read_b64_tr_b16 v[88:89], v12 offset:4096
    ds_read_b64_tr_b16 v[90:91], v12 offset:4352
    s_setprio 0
    v_mfma_f32_32x32x16_bf16 v[128:143], v[52:55], v[44:47], v[128:143]
    s_setprio 2
    s_waitcnt lgkmcnt(10)
    ds_read_b128 v[92:95], v11 offset:928
    ds_read_b128 v[96:99], v11 offset:34208
    ds_read_b64_tr_b16 v[100:101], v12 offset:5120
    ds_read_b64_tr_b16 v[102:103], v12 offset:5376
    s_setprio 0
    v_mfma_f32_32x32x16_bf16 v[144:159], v[52:55], v[48:51], v[144:159]
    s_setprio 2
    s_waitcnt lgkmcnt(8)
    s_setprio 0
    v_mfma_f32_32x32x16_bf16 v[128:143], v[64:67], v[56:59], v[128:143]
    s_setprio 2
    s_setprio 0
    v_mfma_f32_32x32x16_bf16 v[144:159], v[64:67], v[60:63], v[144:159]
    s_setprio 2
    s_waitcnt vmcnt(0)
    ds_read_b128 v[32:35], v11 offset:960
    ds_read_b128 v[36:39], v11 offset:34240
    ds_read_b64_tr_b16 v[40:41], v12 offset:0
    ds_read_b64_tr_b16 v[42:43], v12 offset:256
    s_setprio 0
    v_mfma_f32_32x32x16_bf16 v[128:143], v[76:79], v[68:71], v[128:143]
    s_setprio 2
    s_waitcnt lgkmcnt(10)
    ds_read_b128 v[44:47], v11 offset:992
    ds_read_b128 v[48:51], v11 offset:34272
    ds_read_b64_tr_b16 v[52:53], v12 offset:1024
    ds_read_b64_tr_b16 v[54:55], v12 offset:1280
    s_setprio 0
    v_mfma_f32_32x32x16_bf16 v[144:159], v[76:79], v[72:75], v[144:159]
    s_setprio 2
    s_waitcnt lgkmcnt(8)
    s_setprio 0
    v_mfma_f32_32x32x16_bf16 v[128:143], v[88:91], v[80:83], v[128:143]
    s_setprio 2
    s_setprio 0
    v_mfma_f32_32x32x16_bf16 v[144:159], v[88:91], v[84:87], v[144:159]
    s_setprio 2
    s_setprio 0
    v_mfma_f32_32x32x16_bf16 v[128:143], v[100:103], v[92:95], v[128:143]
    s_setprio 2
    s_setprio 0
    v_mfma_f32_32x32x16_bf16 v[144:159], v[100:103], v[96:99], v[144:159]
    s_setprio 2
    s_waitcnt lgkmcnt(0)
    s_mov_b64 exec, 1
    ds_add_u32 v2, v3 offset:32
    s_mov_b64 exec, -1
    s_lshl_b32 s50, s56, 10
    s_add_u32 s50, s50, 266240
    s_buffer_load_dword s24, s[12:15], s50 offset:0
    s_buffer_load_dword s25, s[12:15], s50 offset:128
    s_buffer_load_dword s26, s[12:15], s50 offset:256
    s_buffer_load_dword s27, s[12:15], s50 offset:384
    s_buffer_load_dword s28, s[12:15], s50 offset:512
    s_buffer_load_dword s29, s[12:15], s50 offset:640
    s_buffer_load_dword s30, s[12:15], s50 offset:768
    s_buffer_load_dword s31, s[12:15], s50 offset:896
    s_add_u32 s50, s50, 8192
    s_setprio 0
    v_mfma_f32_32x32x16_bf16 v[128:143], v[40:43], v[32:35], v[128:143]
    s_setprio 2
    s_setprio 0
    v_mfma_f32_32x32x16_bf16 v[144:159], v[40:43], v[36:39], v[144:159]
    s_setprio 2
    s_setprio 0
    v_mfma_f32_32x32x16_bf16 v[128:143], v[52:55], v[44:47], v[128:143]
    s_setprio 2
    s_setprio 0
    v_mfma_f32_32x32x16_bf16 v[144:159], v[52:55], v[48:51], v[144:159]
    s_setprio 2
    s_nop 11
    v_cvt_pk_bf16_f32 v64, v128, v129
    v_cvt_pk_bf16_f32 v65, v130, v131
    v_cvt_pk_bf16_f32 v66, v132, v133
    v_cvt_pk_bf16_f32 v67, v134, v135
    v_cvt_pk_bf16_f32 v68, v136, v137
    v_cvt_pk_bf16_f32 v69, v138, v139
    v_cvt_pk_bf16_f32 v70, v140, v141
    v_cvt_pk_bf16_f32 v71, v142, v143
    v_pk_max_i16 v64, v64, 0
    v_pk_max_i16 v65, v65, 0
    v_pk_max_i16 v66, v66, 0
    v_pk_max_i16 v67, v67, 0
    v_pk_max_i16 v68, v68, 0
    v_pk_max_i16 v69, v69, 0
    v_pk_max_i16 v70, v70, 0
    v_pk_max_i16 v71, v71, 0
    v_cvt_pk_bf16_f32 v72, v144, v145
    v_cvt_pk_bf16_f32 v73, v146, v147
    v_cvt_pk_bf16_f32 v74, v148, v149
    v_cvt_pk_bf16_f32 v75, v150, v151
    v_cvt_pk_bf16_f32 v76, v152, v153
    v_cvt_pk_bf16_f32 v77, v154, v155
    v_cvt_pk_bf16_f32 v78, v156, v157
    v_cvt_pk_bf16_f32 v79, v158, v159
    v_pk_max_i16 v72, v72, 0
    v_pk_max_i16 v73, v73, 0
    v_pk_max_i16 v74, v74, 0
    v_pk_max_i16 v75, v75, 0
    v_pk_max_i16 v76, v76, 0
    v_pk_max_i16 v77, v77, 0
    v_pk_max_i16 v78, v78, 0
    v_pk_max_i16 v79, v79, 0
L_G1_DONE:
    v_lshl_add_u32 v9, v20, 10, v21
    v_add_u32 v10, 7168, v9
    s_mov_b32 s49, 16384
    v_lshl_add_u32 v12, v24, 9, v23
    v_add_u32 v12, s46, v12
    s_mov_b32 s47, 32768
GN_15:
    v_readfirstlane_b32 s100, v14
    s_sub_u32 s47, s47, 1
    s_cbranch_scc1 GD_16
    s_cmp_lg_u32 s100, 0
    s_cbranch_scc1 GD_16
    buffer_load_dword v14, v15, s[36:39], 0 offen sc1
    s_waitcnt vmcnt(0)
    s_branch GN_15
GD_16:
    s_mov_b32 s101, s100
    s_mov_b32 s47, 14
    s_branch PC_20
PF_17:
    s_buffer_load_dword s24, s[12:15], s50 offset:0
    s_buffer_load_dword s25, s[12:15], s50 offset:128
    s_buffer_load_dword s26, s[12:15], s50 offset:256
    s_buffer_load_dword s27, s[12:15], s50 offset:384
    s_buffer_load_dword s28, s[12:15], s50 offset:512
    s_buffer_load_dword s29, s[12:15], s50 offset:640
    s_buffer_load_dword s30, s[12:15], s50 offset:768
    s_buffer_load_dword s31, s[12:15], s50 offset:896
    s_add_u32 s50, s50, 8192
PC_20:
    s_waitcnt lgkmcnt(0)
    s_xor_b64 s[54:55], s[24:25], s[100:101]
    s_xor_b64 s[26:27], s[26:27], s[100:101]
    s_or_b64 s[54:55], s[54:55], s[26:27]
    s_xor_b64 s[28:29], s[28:29], s[100:101]
    s_or_b64 s[54:55], s[54:55], s[28:29]
    s_xor_b64 s[30:31], s[30:31], s[100:101]
    s_or_b64 s[54:55], s[54:55], s[30:31]
    s_cbranch_scc0 PD_18
    s_sleep 4
    s_sub_u32 s47, s47, 1
    s_cbranch_scc0 PF_17
    v_min_u32 v5, 7, v1
    v_lshlrev_b32 v5, 7, v5
    s_mov_b32 s47, 32768
PV_19:
    buffer_load_dword v4, v5, s[12:15], s50 offen sc1
    s_waitcnt vmcnt(0)
    v_cmp_eq_u32 vcc, s100, v4
    s_sub_u32 s47, s47, 1
    s_cbranch_scc1 PD_18
    s_cmp_eq_u64 vcc, -1
    s_cbranch_scc1 PD_18
    s_sleep 4
    s_branch PV_19
PD_18:
    s_mov_b64 exec, 1
    ds_add_u32 v2, v3 offset:32
    s_mov_b64 exec, -1
    s_mov_b32 s47, 32768
WC_21:
    ds_read_b32 v4, v2 offset:24
    s_waitcnt lgkmcnt(0)
    v_readfirstlane_b32 s43, v4
    s_sub_u32 s47, s47, 1
    s_cbranch_scc1 WD_22
    s_cmp_ge_u32 s43, 4
    s_cbranch_scc1 WD_22
    s_sleep 2
    s_branch WC_21
WD_22:
    s_mov_b32 s47, 32768
WC_23:
    ds_read_b32 v4, v2 offset:32
    s_waitcnt lgkmcnt(0)
    v_readfirstlane_b32 s43, v4
    s_sub_u32 s47, s47, 1
    s_cbranch_scc1 WD_24
    s_cmp_ge_u32 s43, 8
    s_cbranch_scc1 WD_24
    s_sleep 1
    s_branch WC_23
WD_24:
    s_lshl_b32 s43, s56, 12
    s_add_u32 s48, s43, 67584
    s_add_u32 m0, s43, 67584
    s_nop 0
    buffer_load_dwordx4 v8, s[12:15], s48 offen offset:0 sc1 lds
    buffer_load_dwordx4 v8, s[12:15], s48 offen offset:1024 sc1 lds
    buffer_load_dwordx4 v8, s[12:15], s48 offen offset:2048 sc1 lds
    buffer_load_dwordx4 v8, s[12:15], s48 offen offset:3072 sc1 lds
    s_add_u32 s48, s48, 16384
    s_add_u32 m0, m0, 16384
    s_nop 0
    buffer_load_dwordx4 v8, s[12:15], s48 offen offset:0 sc1 lds
    buffer_load_dwordx4 v8, s[12:15], s48 offen offset:1024 sc1 lds
    buffer_load_dwordx4 v8, s[12:15], s48 offen offset:2048 sc1 lds
    buffer_load_dwordx4 v8, s[12:15], s48 offen offset:3072 sc1 lds
    s_add_u32 s48, s48, 16384
    s_add_u32 m0, m0, 16384
    s_cmp_lg_u32 s56, 0
    s_cbranch_scc1 KD_25
    buffer_load_dwordx4 v8, s[12:15], s48 offen sc1 lds
KD_25:
    s_lshl_b32 s43, s56, 12
    s_add_u32 s48, s43, 101376
    s_add_u32 m0, s43, 101376
    s_nop 0
    buffer_load_dwordx4 v8, s[12:15], s48 offen offset:0 sc1 lds
    buffer_load_dwordx4 v8, s[12:15], s48 offen offset:1024 sc1 lds
    buffer_load_dwordx4 v8, s[12:15], s48 offen offset:2048 sc1 lds
    buffer_load_dwordx4 v8, s[12:15], s48 offen offset:3072 sc1 lds
    s_add_u32 s48, s48, 16384
    s_add_u32 m0, m0, 16384
    s_nop 0
    buffer_load_dwordx4 v8, s[12:15], s48 offen offset:0 sc1 lds
    buffer_load_dwordx4 v8, s[12:15], s48 offen offset:1024 sc1 lds
    buffer_load_dwordx4 v8, s[12:15], s48 offen offset:2048 sc1 lds
    buffer_load_dwordx4 v8, s[12:15], s48 offen offset:3072 sc1 lds
    s_add_u32 s48, s48, 16384
    s_add_u32 m0, m0, 16384
    s_cmp_lg_u32 s56, 0
    s_cbranch_scc1 KD_26
    buffer_load_dwordx4 v8, s[12:15], s48 offen sc1 lds
KD_26:
    s_lshl_b32 s43, s57, 12
    s_add_u32 s44, s43, s51
    s_add_u32 s45, s44, 4096
    s_waitcnt vmcnt(0)
    s_mov_b64 exec, 1
    ds_add_u32 v2, v3 offset:4
    s_mov_b64 exec, -1
    buffer_store_dwordx4 v[64:67], v8, s[12:15], s44 offen offset:0 sc1
    buffer_store_dwordx4 v[68:71], v8, s[12:15], s44 offen offset:2048 sc1
    buffer_store_dwordx4 v[72:75], v8, s[12:15], s44 offen offset:1024 sc1
    buffer_store_dwordx4 v[76:79], v8, s[12:15], s44 offen offset:3072 sc1
    s_cmp_eq_u32 s97, 0
    s_cbranch_scc1 L_HS1
    buffer_store_dwordx4 v[80:83], v8, s[12:15], s45 offen offset:0 sc1
    buffer_store_dwordx4 v[84:87], v8, s[12:15], s45 offen offset:2048 sc1
    buffer_store_dwordx4 v[88:91], v8, s[12:15], s45 offen offset:1024 sc1
    buffer_store_dwordx4 v[92:95], v8, s[12:15], s45 offen offset:3072 sc1
L_HS1:
    v_lshrrev_b32 v100, 2, v1
    v_and_b32 v4, 3, v1
    v_lshlrev_b32 v4, 7, v4
    v_and_b32 v101, 3, v100
    v_lshl_add_u32 v100, v100, 10, v4
    v_lshl_add_u32 v101, v101, 10, v4
    s_lshr_b32 s60, s42, 2
    s_lshl_b32 s60, s60, 9
    s_mul_i32 s43, s96, 57344
    s_lshl_b32 s45, s56, 14
    s_add_u32 s43, s43, s45
    s_add_u32 s43, s43, s60
    v_add_u32 v100, s43, v100
    s_lshl_b32 s43, s96, 14
    s_lshl_b32 s45, s56, 12
    s_add_u32 s43, s43, s45
    s_add_u32 s43, s43, s60
    v_add_u32 v101, s43, v101
    s_lshl_b32 s44, s42, 9
    s_lshl_b32 s45, s56, 7
    s_add_u32 s44, s44, s45
    s_add_u32 s44, s44, s52
    s_waitcnt vmcnt(0)
    v_lshlrev_b32 v4, 12, v1
    s_mov_b64 exec, 65535
    buffer_store_dword v14, v4, s[12:15], s44 offen sc1
    s_mov_b64 exec, -1
    s_mov_b64 exec, 1
    ds_add_u32 v2, v3 offset:8
    s_mov_b64 exec, -1
    buffer_load_dword v210, v100, s[20:23], 0 offen
    buffer_load_dword v210, v101, s[16:19], 0 offen
    s_lshl_b32 s48, s56, 17
    s_lshl_b32 s43, s42, 7
    s_add_u32 s48, s48, s43
    s_add_u32 m0, s46, 0
    s_nop 0
    buffer_load_dwordx4 v9, s[16:19], s48 offen lds
    buffer_load_dwordx4 v10, s[16:19], s48 offen offset:1024 lds
    s_add_u32 s48, s48, s49
    s_add_u32 m0, s46, 2048
    s_nop 0
    buffer_load_dwordx4 v9, s[16:19], s48 offen lds
    buffer_load_dwordx4 v10, s[16:19], s48 offen offset:1024 lds
    s_add_u32 s48, s48, s49
    s_add_u32 m0, s46, 4096
    s_nop 0
    buffer_load_dwordx4 v9, s[16:19], s48 offen lds
    buffer_load_dwordx4 v10, s[16:19], s48 offen offset:1024 lds
    s_add_u32 s48, s48, s49
    s_waitcnt vmcnt(4)
    ds_read_b64_tr_b16 v[192:193], v12 offset:0
    ds_read_b64_tr_b16 v[194:195], v12 offset:1024
    ds_read_b64_tr_b16 v[196:197], v12 offset:256
    ds_read_b64_tr_b16 v[198:199], v12 offset:1280
    s_waitcnt lgkmcnt(0)
    s_add_u32 m0, s46, 0
    s_nop 0
    buffer_load_dwordx4 v9, s[16:19], s48 offen lds
    buffer_load_dwordx4 v10, s[16:19], s48 offen offset:1024 lds
    s_add_u32 s48, s48, s49
    s_waitcnt vmcnt(4)
    ds_read_b64_tr_b16 v[200:201], v12 offset:2048
    ds_read_b64_tr_b16 v[202:203], v12 offset:3072
    ds_read_b64_tr_b16 v[204:205], v12 offset:2304
    ds_read_b64_tr_b16 v[206:207], v12 offset:3328
    s_waitcnt lgkmcnt(0)
    s_add_u32 m0, s46, 2048
    s_nop 0
    buffer_load_dwordx4 v9, s[16:19], s48 offen lds
    buffer_load_dwordx4 v10, s[16:19], s48 offen offset:1024 lds
    s_add_u32 s48, s48, s49
    s_waitcnt vmcnt(4)
    ds_read_b64_tr_b16 v[208:209], v12 offset:4096
    ds_read_b64_tr_b16 v[210:211], v12 offset:5120
    ds_read_b64_tr_b16 v[212:213], v12 offset:4352
    ds_read_b64_tr_b16 v[214:215], v12 offset:5376
    s_waitcnt lgkmcnt(0)
    s_add_u32 m0, s46, 4096
    s_nop 0
    buffer_load_dwordx4 v9, s[16:19], s48 offen lds
    buffer_load_dwordx4 v10, s[16:19], s48 offen offset:1024 lds
    s_add_u32 s48, s48, s49
    s_waitcnt vmcnt(4)
    ds_read_b64_tr_b16 v[216:217], v12 offset:0
    ds_read_b64_tr_b16 v[218:219], v12 offset:1024
    ds_read_b64_tr_b16 v[220:221], v12 offset:256
    ds_read_b64_tr_b16 v[222:223], v12 offset:1280
    s_waitcnt lgkmcnt(0)
    s_add_u32 m0, s46, 0
    s_nop 0
    buffer_load_dwordx4 v9, s[16:19], s48 offen lds
    buffer_load_dwordx4 v10, s[16:19], s48 offen offset:1024 lds
    s_add_u32 s48, s48, s49
    s_waitcnt vmcnt(4)
    ds_read_b64_tr_b16 v[224:225], v12 offset:2048
    ds_read_b64_tr_b16 v[226:227], v12 offset:3072
    ds_read_b64_tr_b16 v[228:229], v12 offset:2304
    ds_read_b64_tr_b16 v[230:231], v12 offset:3328
    s_waitcnt lgkmcnt(0)
    s_add_u32 m0, s46, 2048
    s_nop 0
    buffer_load_dwordx4 v9, s[16:19], s48 offen lds
    buffer_load_dwordx4 v10, s[16:19], s48 offen offset:1024 lds
    s_add_u32 s48, s48, s49
    s_waitcnt vmcnt(4)
    ds_read_b64_tr_b16 v[232:233], v12 offset:4096
    ds_read_b64_tr_b16 v[234:235], v12 offset:5120
    ds_read_b64_tr_b16 v[236:237], v12 offset:4352
    ds_read_b64_tr_b16 v[238:239], v12 offset:5376
    s_waitcnt lgkmcnt(0)
    s_mul_i32 s48, s56, 458752
    s_lshl_b32 s43, s42, 7
    s_add_u32 s48, s48, s43
    s_add_u32 m0, s46, 4096
    s_nop 0
    buffer_load_dwordx4 v9, s[20:23], s48 offen lds
    buffer_load_dwordx4 v10, s[20:23], s48 offen offset:1024 lds
    s_add_u32 s48, s48, s49
    s_waitcnt vmcnt(4)
    ds_read_b64_tr_b16 v[240:241], v12 offset:0
    ds_read_b64_tr_b16 v[242:243], v12 offset:1024
    ds_read_b64_tr_b16 v[244:245], v12 offset:256
    ds_read_b64_tr_b16 v[246:247], v12 offset:1280
    s_waitcnt lgkmcnt(0)
    s_add_u32 m0, s46, 0
    s_nop 0
    buffer_load_dwordx4 v9, s[20:23], s48 offen lds
    buffer_load_dwordx4 v10, s[20:23], s48 offen offset:1024 lds
    s_add_u32 s48, s48, s49
    s_waitcnt vmcnt(4)
    ds_read_b64_tr_b16 v[248:249], v12 offset:2048
    ds_read_b64_tr_b16 v[250:251], v12 offset:3072
    ds_read_b64_tr_b16 v[252:253], v12 offset:2304
    ds_read_b64_tr_b16 v[254:255], v12 offset:3328
    s_waitcnt lgkmcnt(0)
    s_add_u32 m0, s46, 2048
    s_nop 0
    buffer_load_dwordx4 v9, s[20:23], s48 offen lds
    buffer_load_dwordx4 v10, s[20:23], s48 offen offset:1024 lds
    s_add_u32 s48, s48, s49
    s_and_b32 s43, s56, 2
    s_add_u32 s43, s43, s56
    s_lshl_b32 s43, s43, 9
    s_add_u32 s44, s52, s43
    s_mov_b32 s47, 14
PF_27:
    s_buffer_load_dword s24, s[12:15], s44 offset:0
    s_buffer_load_dword s25, s[12:15], s44 offset:128
    s_buffer_load_dword s26, s[12:15], s44 offset:256
    s_buffer_load_dword s27, s[12:15], s44 offset:384
    s_buffer_load_dword s28, s[12:15], s44 offset:512
    s_buffer_load_dword s29, s[12:15], s44 offset:640
    s_buffer_load_dword s30, s[12:15], s44 offset:768
    s_buffer_load_dword s31, s[12:15], s44 offset:896
    s_buffer_load_dword s32, s[12:15], s44 offset:1024
    s_buffer_load_dword s33, s[12:15], s44 offset:1152
    s_buffer_load_dword s34, s[12:15], s44 offset:1280
    s_buffer_load_dword s35, s[12:15], s44 offset:1408
    s_add_u32 s44, s44, 4096
PC_30:
    s_waitcnt lgkmcnt(0)
    s_xor_b64 s[54:55], s[24:25], s[100:101]
    s_xor_b64 s[26:27], s[26:27], s[100:101]
    s_or_b64 s[54:55], s[54:55], s[26:27]
    s_xor_b64 s[28:29], s[28:29], s[100:101]
    s_or_b64 s[54:55], s[54:55], s[28:29]
    s_xor_b64 s[30:31], s[30:31], s[100:101]
    s_or_b64 s[54:55], s[54:55], s[30:31]
    s_xor_b64 s[32:33], s[32:33], s[100:101]
    s_or_b64 s[54:55], s[54:55], s[32:33]
    s_xor_b64 s[34:35], s[34:35], s[100:101]
    s_or_b64 s[54:55], s[54:55], s[34:35]
    s_cbranch_scc0 PD_28
    s_sleep 8
    s_sub_u32 s47, s47, 1
    s_cbranch_scc0 PF_27
    v_min_u32 v5, 11, v1
    v_lshlrev_b32 v5, 7, v5
    s_mov_b32 s47, 32768
PV_29:
    buffer_load_dword v4, v5, s[12:15], s44 offen sc1
    s_waitcnt vmcnt(0)
    v_cmp_eq_u32 vcc, s100, v4
    s_sub_u32 s47, s47, 1
    s_cbranch_scc1 PD_28
    s_cmp_eq_u64 vcc, -1
    s_cbranch_scc1 PD_28
    s_sleep 4
    s_branch PV_29
PD_28:
    s_setprio 0
    s_mul_i32 s50, s56, 57344
    s_add_u32 s50, s50, s51
    buffer_load_dwordx4 v[120:123], v8, s[12:15], s50 offen sc1
    buffer_load_dwordx4 v[124:127], v8, s[12:15], s50 offen offset:1024 sc1
    s_add_u32 s50, s50, 2048
    buffer_load_dwordx4 v[112:115], v8, s[12:15], s50 offen sc1
    buffer_load_dwordx4 v[116:119], v8, s[12:15], s50 offen offset:1024 sc1
    s_add_u32 s50, s50, 2048
    buffer_load_dwordx4 v[104:107], v8, s[12:15], s50 offen sc1
    buffer_load_dwordx4 v[108:111], v8, s[12:15], s50 offen offset:1024 sc1
    s_add_u32 s50, s50, 2048
    buffer_load_dwordx4 v[96:99], v8, s[12:15], s50 offen sc1
    buffer_load_dwordx4 v[100:103], v8, s[12:15], s50 offen offset:1024 sc1
    s_add_u32 s50, s50, 2048
    buffer_load_dwordx4 v[88:91], v8, s[12:15], s50 offen sc1
    buffer_load_dwordx4 v[92:95], v8, s[12:15], s50 offen offset:1024 sc1
    s_add_u32 s50, s50, 2048
    buffer_load_dwordx4 v[80:83], v8, s[12:15], s50 offen sc1
    buffer_load_dwordx4 v[84:87], v8, s[12:15], s50 offen offset:1024 sc1
    s_add_u32 s50, s50, 2048
    s_mov_b32 s47, 32768
WC_31:
    ds_read_b32 v4, v2 offset:56
    s_waitcnt lgkmcnt(0)
    v_readfirstlane_b32 s43, v4
    s_sub_u32 s47, s47, 1
    s_cbranch_scc1 WD_32
    s_cmp_ge_u32 s43, 9
    s_cbranch_scc1 WD_32
    s_sleep 8
    s_branch WC_31
WD_32:
    s_waitcnt vmcnt(16)
    ds_read_b64_tr_b16 v[32:33], v12 offset:4096
    ds_read_b64_tr_b16 v[34:35], v12 offset:5120
    ds_read_b64_tr_b16 v[36:37], v12 offset:4352
    ds_read_b64_tr_b16 v[38:39], v12 offset:5376
    s_waitcnt lgkmcnt(0)
    s_add_u32 m0, s46, 4096
    s_nop 0
    buffer_load_dwordx4 v9, s[20:23], s48 offen lds
    buffer_load_dwordx4 v10, s[20:23], s48 offen offset:1024 lds
    s_add_u32 s48, s48, s49
    s_waitcnt vmcnt(16)
    ds_read_b64_tr_b16 v[40:41], v12 offset:0
    ds_read_b64_tr_b16 v[42:43], v12 offset:1024
    ds_read_b64_tr_b16 v[44:45], v12 offset:256
    ds_read_b64_tr_b16 v[46:47], v12 offset:1280
    buffer_load_dwordx4 v[72:75], v8, s[12:15], s50 offen sc1
    buffer_load_dwordx4 v[76:79], v8, s[12:15], s50 offen offset:1024 sc1
    s_add_u32 s50, s50, 2048
    s_waitcnt vmcnt(14)
    v_mfma_f32_32x32x16_bf16 v[128:143], v[32:35], v[120:123], 0
    v_mfma_f32_32x32x16_bf16 v[144:159], v[32:35], v[124:127], 0
    v_mfma_f32_32x32x16_bf16 v[160:175], v[36:39], v[120:123], 0
    v_mfma_f32_32x32x16_bf16 v[176:191], v[36:39], v[124:127], 0
    s_waitcnt lgkmcnt(0)
    s_add_u32 m0, s46, 0
    s_nop 0
    buffer_load_dwordx4 v9, s[20:23], s48 offen lds
    buffer_load_dwordx4 v10, s[20:23], s48 offen offset:1024 lds
    s_add_u32 s48, s48, s49
    s_waitcnt vmcnt(18)
    ds_read_b64_tr_b16 v[32:33], v12 offset:2048
    ds_read_b64_tr_b16 v[34:35], v12 offset:3072
    ds_read_b64_tr_b16 v[36:37], v12 offset:2304
    ds_read_b64_tr_b16 v[38:39], v12 offset:3328
    buffer_load_dwordx4 v[120:123], v8, s[12:15], s50 offen sc1
    buffer_load_dwordx4 v[124:127], v8, s[12:15], s50 offen offset:1024 sc1
    s_add_u32 s50, s50, 2048
    s_waitcnt vmcnt(16)
    v_mfma_f32_32x32x16_bf16 v[128:143], v[40:43], v[112:115], v[128:143]
    v_mfma_f32_32x32x16_bf16 v[144:159], v[40:43], v[116:119], v[144:159]
    v_mfma_f32_32x32x16_bf16 v[160:175], v[44:47], v[112:115], v[160:175]
    v_mfma_f32_32x32x16_bf16 v[176:191], v[44:47], v[116:119], v[176:191]
    s_waitcnt lgkmcnt(0)
    s_add_u32 m0, s46, 2048
    s_nop 0
    buffer_load_dwordx4 v9, s[20:23], s48 offen lds
    buffer_load_dwordx4 v10, s[20:23], s48 offen offset:1024 lds
    s_add_u32 s48, s48, s49
    s_waitcnt vmcnt(8)
    ds_read_b64_tr_b16 v[40:41], v12 offset:4096
    ds_read_b64_tr_b16 v[42:43], v12 offset:5120
    ds_read_b64_tr_b16 v[44:45], v12 offset:4352
    ds_read_b64_tr_b16 v[46:47], v12 offset:5376
    buffer_load_dwordx4 v[112:115], v8, s[12:15], s50 offen sc1
    buffer_load_dwordx4 v[116:119], v8, s[12:15], s50 offen offset:1024 sc1
    s_add_u32 s50, s50, 2048
    s_waitcnt vmcnt(18)
    v_mfma_f32_32x32x16_bf16 v[128:143], v[32:35], v[104:107], v[128:143]
    v_mfma_f32_32x32x16_bf16 v[144:159], v[32:35], v[108:111], v[144:159]
    v_mfma_f32_32x32x16_bf16 v[160:175], v[36:39], v[104:107], v[160:175]
    v_mfma_f32_32x32x16_bf16 v[176:191], v[36:39], v[108:111], v[176:191]
    s_waitcnt lgkmcnt(0)
    s_add_u32 m0, s46, 4096
    s_nop 0
    buffer_load_dwordx4 v9, s[20:23], s48 offen lds
    buffer_load_dwordx4 v10, s[20:23], s48 offen offset:1024 lds
    s_add_u32 s48, s48, s49
    s_waitcnt vmcnt(8)
    ds_read_b64_tr_b16 v[32:33], v12 offset:0
    ds_read_b64_tr_b16 v[34:35], v12 offset:1024
    ds_read_b64_tr_b16 v[36:37], v12 offset:256
    ds_read_b64_tr_b16 v[38:39], v12 offset:1280
    buffer_load_dwordx4 v[104:107], v8, s[12:15], s50 offen sc1
    buffer_load_dwordx4 v[108:111], v8, s[12:15], s50 offen offset:1024 sc1
    s_add_u32 s50, s50, 2048
    s_waitcnt vmcnt(20)
    v_mfma_f32_32x32x16_bf16 v[128:143], v[40:43], v[96:99], v[128:143]
    v_mfma_f32_32x32x16_bf16 v[144:159], v[40:43], v[100:103], v[144:159]
    v_mfma_f32_32x32x16_bf16 v[160:175], v[44:47], v[96:99], v[160:175]
    v_mfma_f32_32x32x16_bf16 v[176:191], v[44:47], v[100:103], v[176:191]
    s_waitcnt lgkmcnt(0)
    s_add_u32 m0, s46, 0
    s_nop 0
    buffer_load_dwordx4 v9, s[20:23], s48 offen lds
    buffer_load_dwordx4 v10, s[20:23], s48 offen offset:1024 lds
    s_add_u32 s48, s48, s49
    s_waitcnt vmcnt(8)
    ds_read_b64_tr_b16 v[40:41], v12 offset:2048
    ds_read_b64_tr_b16 v[42:43], v12 offset:3072
    ds_read_b64_tr_b16 v[44:45], v12 offset:2304
    ds_read_b64_tr_b16 v[46:47], v12 offset:3328
    buffer_load_dwordx4 v[96:99], v8, s[12:15], s50 offen sc1
    buffer_load_dwordx4 v[100:103], v8, s[12:15], s50 offen offset:1024 sc1
    s_add_u32 s50, s50, 2048
    s_waitcnt vmcnt(22)
    v_mfma_f32_32x32x16_bf16 v[128:143], v[32:35], v[88:91], v[128:143]
    v_mfma_f32_32x32x16_bf16 v[144:159], v[32:35], v[92:95], v[144:159]
    v_mfma_f32_32x32x16_bf16 v[160:175], v[36:39], v[88:91], v[160:175]
    v_mfma_f32_32x32x16_bf16 v[176:191], v[36:39], v[92:95], v[176:191]
    s_waitcnt lgkmcnt(0)
    s_add_u32 m0, s46, 2048
    s_nop 0
    buffer_load_dwordx4 v9, s[20:23], s48 offen lds
    buffer_load_dwordx4 v10, s[20:23], s48 offen offset:1024 lds
    s_add_u32 s48, s48, s49
    s_waitcnt vmcnt(8)
    ds_read_b64_tr_b16 v[32:33], v12 offset:4096
    ds_read_b64_tr_b16 v[34:35], v12 offset:5120
    ds_read_b64_tr_b16 v[36:37], v12 offset:4352
    ds_read_b64_tr_b16 v[38:39], v12 offset:5376
    buffer_load_dwordx4 v[88:91], v8, s[12:15], s50 offen sc1
    buffer_load_dwordx4 v[92:95], v8, s[12:15], s50 offen offset:1024 sc1
    s_add_u32 s50, s50, 2048
    s_waitcnt vmcnt(24)
    v_mfma_f32_32x32x16_bf16 v[128:143], v[40:43], v[80:83], v[128:143]
    v_mfma_f32_32x32x16_bf16 v[144:159], v[40:43], v[84:87], v[144:159]
    v_mfma_f32_32x32x16_bf16 v[160:175], v[44:47], v[80:83], v[160:175]
    v_mfma_f32_32x32x16_bf16 v[176:191], v[44:47], v[84:87], v[176:191]
    s_waitcnt lgkmcnt(0)
    s_add_u32 m0, s46, 4096
    s_nop 0
    buffer_load_dwordx4 v9, s[20:23], s48 offen lds
    buffer_load_dwordx4 v10, s[20:23], s48 offen offset:1024 lds
    s_add_u32 s48, s48, s49
    s_waitcnt vmcnt(8)
    ds_read_b64_tr_b16 v[40:41], v12 offset:0
    ds_read_b64_tr_b16 v[42:43], v12 offset:1024
    ds_read_b64_tr_b16 v[44:45], v12 offset:256
    ds_read_b64_tr_b16 v[46:47], v12 offset:1280
    buffer_load_dwordx4 v[80:83], v8, s[12:15], s50 offen sc1
    buffer_load_dwordx4 v[84:87], v8, s[12:15], s50 offen offset:1024 sc1
    s_add_u32 s50, s50, 2048
    s_waitcnt vmcnt(24)
    v_mfma_f32_32x32x16_bf16 v[128:143], v[32:35], v[72:75], v[128:143]
    v_mfma_f32_32x32x16_bf16 v[144:159], v[32:35], v[76:79], v[144:159]
    v_mfma_f32_32x32x16_bf16 v[160:175], v[36:39], v[72:75], v[160:175]
    v_mfma_f32_32x32x16_bf16 v[176:191], v[36:39], v[76:79], v[176:191]
    s_waitcnt lgkmcnt(0)
    s_add_u32 m0, s46, 0
    s_nop 0
    buffer_load_dwordx4 v9, s[20:23], s48 offen lds
    buffer_load_dwordx4 v10, s[20:23], s48 offen offset:1024 lds
    s_add_u32 s48, s48, s49
    s_waitcnt vmcnt(8)
    ds_read_b64_tr_b16 v[32:33], v12 offset:2048
    ds_read_b64_tr_b16 v[34:35], v12 offset:3072
    ds_read_b64_tr_b16 v[36:37], v12 offset:2304
    ds_read_b64_tr_b16 v[38:39], v12 offset:3328
    buffer_load_dwordx4 v[72:75], v8, s[12:15], s50 offen sc1
    buffer_load_dwordx4 v[76:79], v8, s[12:15], s50 offen offset:1024 sc1
    s_add_u32 s50, s50, 2048
    s_waitcnt vmcnt(24)
    v_mfma_f32_32x32x16_bf16 v[128:143], v[40:43], v[120:123], v[128:143]
    v_mfma_f32_32x32x16_bf16 v[144:159], v[40:43], v[124:127], v[144:159]
    v_mfma_f32_32x32x16_bf16 v[160:175], v[44:47], v[120:123], v[160:175]
    v_mfma_f32_32x32x16_bf16 v[176:191], v[44:47], v[124:127], v[176:191]
    s_waitcnt lgkmcnt(0)
    s_add_u32 m0, s46, 2048
    s_nop 0
    buffer_load_dwordx4 v9, s[20:23], s48 offen lds
    buffer_load_dwordx4 v10, s[20:23], s48 offen offset:1024 lds
    s_add_u32 s48, s48, s49
    s_waitcnt vmcnt(8)
    ds_read_b64_tr_b16 v[40:41], v12 offset:4096
    ds_read_b64_tr_b16 v[42:43], v12 offset:5120
    ds_read_b64_tr_b16 v[44:45], v12 offset:4352
    ds_read_b64_tr_b16 v[46:47], v12 offset:5376
    buffer_load_dwordx4 v[120:123], v8, s[12:15], s50 offen sc1
    buffer_load_dwordx4 v[124:127], v8, s[12:15], s50 offen offset:1024 sc1
    s_add_u32 s50, s50, 2048
    s_waitcnt vmcnt(24)
    v_mfma_f32_32x32x16_bf16 v[128:143], v[32:35], v[112:115], v[128:143]
    v_mfma_f32_32x32x16_bf16 v[144:159], v[32:35], v[116:119], v[144:159]
    v_mfma_f32_32x32x16_bf16 v[160:175], v[36:39], v[112:115], v[160:175]
    v_mfma_f32_32x32x16_bf16 v[176:191], v[36:39], v[116:119], v[176:191]
    s_waitcnt lgkmcnt(0)
    s_add_u32 m0, s46, 4096
    s_nop 0
    buffer_load_dwordx4 v9, s[20:23], s48 offen lds
    buffer_load_dwordx4 v10, s[20:23], s48 offen offset:1024 lds
    s_add_u32 s48, s48, s49
    s_waitcnt vmcnt(8)
    ds_read_b64_tr_b16 v[32:33], v12 offset:0
    ds_read_b64_tr_b16 v[34:35], v12 offset:1024
    ds_read_b64_tr_b16 v[36:37], v12 offset:256
    ds_read_b64_tr_b16 v[38:39], v12 offset:1280
    buffer_load_dwordx4 v[112:115], v8, s[12:15], s50 offen sc1
    buffer_load_dwordx4 v[116:119], v8, s[12:15], s50 offen offset:1024 sc1
    s_add_u32 s50, s50, 2048
    s_waitcnt vmcnt(24)
    v_mfma_f32_32x32x16_bf16 v[128:143], v[40:43], v[104:107], v[128:143]
    v_mfma_f32_32x32x16_bf16 v[144:159], v[40:43], v[108:111], v[144:159]
    v_mfma_f32_32x32x16_bf16 v[160:175], v[44:47], v[104:107], v[160:175]
    v_mfma_f32_32x32x16_bf16 v[176:191], v[44:47], v[108:111], v[176:191]
    s_waitcnt lgkmcnt(0)
    s_add_u32 m0, s46, 0
    s_nop 0
    buffer_load_dwordx4 v9, s[20:23], s48 offen lds
    buffer_load_dwordx4 v10, s[20:23], s48 offen offset:1024 lds
    s_add_u32 s48, s48, s49
    s_waitcnt vmcnt(8)
    ds_read_b64_tr_b16 v[40:41], v12 offset:2048
    ds_read_b64_tr_b16 v[42:43], v12 offset:3072
    ds_read_b64_tr_b16 v[44:45], v12 offset:2304
    ds_read_b64_tr_b16 v[46:47], v12 offset:3328
    buffer_load_dwordx4 v[104:107], v8, s[12:15], s50 offen sc1
    buffer_load_dwordx4 v[108:111], v8, s[12:15], s50 offen offset:1024 sc1
    s_add_u32 s50, s50, 2048
    s_waitcnt vmcnt(24)
    v_mfma_f32_32x32x16_bf16 v[128:143], v[32:35], v[96:99], v[128:143]
    v_mfma_f32_32x32x16_bf16 v[144:159], v[32:35], v[100:103], v[144:159]
    v_mfma_f32_32x32x16_bf16 v[160:175], v[36:39], v[96:99], v[160:175]
    v_mfma_f32_32x32x16_bf16 v[176:191], v[36:39], v[100:103], v[176:191]
    s_waitcnt lgkmcnt(0)
    s_add_u32 m0, s46, 2048
    s_nop 0
    buffer_load_dwordx4 v9, s[20:23], s48 offen lds
    buffer_load_dwordx4 v10, s[20:23], s48 offen offset:1024 lds
    s_add_u32 s48, s48, s49
    s_waitcnt vmcnt(8)
    ds_read_b64_tr_b16 v[32:33], v12 offset:4096
    ds_read_b64_tr_b16 v[34:35], v12 offset:5120
    ds_read_b64_tr_b16 v[36:37], v12 offset:4352
    ds_read_b64_tr_b16 v[38:39], v12 offset:5376
    buffer_load_dwordx4 v[96:99], v8, s[12:15], s50 offen sc1
    buffer_load_dwordx4 v[100:103], v8, s[12:15], s50 offen offset:1024 sc1
    s_add_u32 s50, s50, 2048
    s_waitcnt vmcnt(24)
    v_mfma_f32_32x32x16_bf16 v[128:143], v[40:43], v[88:91], v[128:143]
    v_mfma_f32_32x32x16_bf16 v[144:159], v[40:43], v[92:95], v[144:159]
    v_mfma_f32_32x32x16_bf16 v[160:175], v[44:47], v[88:91], v[160:175]
    v_mfma_f32_32x32x16_bf16 v[176:191], v[44:47], v[92:95], v[176:191]
    s_waitcnt lgkmcnt(0)
    s_add_u32 m0, s46, 4096
    s_nop 0
    buffer_load_dwordx4 v9, s[20:23], s48 offen lds
    buffer_load_dwordx4 v10, s[20:23], s48 offen offset:1024 lds
    s_add_u32 s48, s48, s49
    s_waitcnt vmcnt(8)
    ds_read_b64_tr_b16 v[40:41], v12 offset:0
    ds_read_b64_tr_b16 v[42:43], v12 offset:1024
    ds_read_b64_tr_b16 v[44:45], v12 offset:256
    ds_read_b64_tr_b16 v[46:47], v12 offset:1280
    buffer_load_dwordx4 v[88:91], v8, s[12:15], s50 offen sc1
    buffer_load_dwordx4 v[92:95], v8, s[12:15], s50 offen offset:1024 sc1
    s_add_u32 s50, s50, 2048
    s_waitcnt vmcnt(24)
    v_mfma_f32_32x32x16_bf16 v[128:143], v[32:35], v[80:83], v[128:143]
    v_mfma_f32_32x32x16_bf16 v[144:159], v[32:35], v[84:87], v[144:159]
    v_mfma_f32_32x32x16_bf16 v[160:175], v[36:39], v[80:83], v[160:175]
    v_mfma_f32_32x32x16_bf16 v[176:191], v[36:39], v[84:87], v[176:191]
    s_waitcnt lgkmcnt(0)
    s_add_u32 m0, s46, 0
    s_nop 0
    buffer_load_dwordx4 v9, s[20:23], s48 offen lds
    buffer_load_dwordx4 v10, s[20:23], s48 offen offset:1024 lds
    s_add_u32 s48, s48, s49
    s_waitcnt vmcnt(8)
    ds_read_b64_tr_b16 v[32:33], v12 offset:2048
    ds_read_b64_tr_b16 v[34:35], v12 offset:3072
    ds_read_b64_tr_b16 v[36:37], v12 offset:2304
    ds_read_b64_tr_b16 v[38:39], v12 offset:3328
    buffer_load_dwordx4 v[80:83], v8, s[12:15], s50 offen sc1
    buffer_load_dwordx4 v[84:87], v8, s[12:15], s50 offen offset:1024 sc1
    s_add_u32 s50, s50, 2048
    s_waitcnt vmcnt(24)
    v_mfma_f32_32x32x16_bf16 v[128:143], v[40:43], v[72:75], v[128:143]
    v_mfma_f32_32x32x16_bf16 v[144:159], v[40:43], v[76:79], v[144:159]
    v_mfma_f32_32x32x16_bf16 v[160:175], v[44:47], v[72:75], v[160:175]
    v_mfma_f32_32x32x16_bf16 v[176:191], v[44:47], v[76:79], v[176:191]
    s_waitcnt lgkmcnt(0)
    s_add_u32 m0, s46, 2048
    s_nop 0
    buffer_load_dwordx4 v9, s[20:23], s48 offen lds
    buffer_load_dwordx4 v10, s[20:23], s48 offen offset:1024 lds
    s_add_u32 s48, s48, s49
    s_waitcnt vmcnt(8)
    ds_read_b64_tr_b16 v[40:41], v12 offset:4096
    ds_read_b64_tr_b16 v[42:43], v12 offset:5120
    ds_read_b64_tr_b16 v[44:45], v12 offset:4352
    ds_read_b64_tr_b16 v[46:47], v12 offset:5376
    buffer_load_dwordx4 v[72:75], v8, s[12:15], s50 offen sc1
    buffer_load_dwordx4 v[76:79], v8, s[12:15], s50 offen offset:1024 sc1
    s_add_u32 s50, s50, 2048
    s_waitcnt vmcnt(24)
    v_mfma_f32_32x32x16_bf16 v[128:143], v[32:35], v[120:123], v[128:143]
    v_mfma_f32_32x32x16_bf16 v[144:159], v[32:35], v[124:127], v[144:159]
    v_mfma_f32_32x32x16_bf16 v[160:175], v[36:39], v[120:123], v[160:175]
    v_mfma_f32_32x32x16_bf16 v[176:191], v[36:39], v[124:127], v[176:191]
    s_waitcnt lgkmcnt(0)
    s_add_u32 m0, s46, 4096
    s_nop 0
    buffer_load_dwordx4 v9, s[20:23], s48 offen lds
    buffer_load_dwordx4 v10, s[20:23], s48 offen offset:1024 lds
    s_add_u32 s48, s48, s49
    s_waitcnt vmcnt(8)
    ds_read_b64_tr_b16 v[32:33], v12 offset:0
    ds_read_b64_tr_b16 v[34:35], v12 offset:1024
    ds_read_b64_tr_b16 v[36:37], v12 offset:256
    ds_read_b64_tr_b16 v[38:39], v12 offset:1280
    buffer_load_dwordx4 v[120:123], v8, s[12:15], s50 offen sc1
    buffer_load_dwordx4 v[124:127], v8, s[12:15], s50 offen offset:1024 sc1
    s_add_u32 s50, s50, 2048
    s_waitcnt vmcnt(24)
    v_mfma_f32_32x32x16_bf16 v[128:143], v[40:43], v[112:115], v[128:143]
    v_mfma_f32_32x32x16_bf16 v[144:159], v[40:43], v[116:119], v[144:159]
    v_mfma_f32_32x32x16_bf16 v[160:175], v[44:47], v[112:115], v[160:175]
    v_mfma_f32_32x32x16_bf16 v[176:191], v[44:47], v[116:119], v[176:191]
    s_waitcnt lgkmcnt(0)
    s_add_u32 m0, s46, 0
    s_nop 0
    buffer_load_dwordx4 v9, s[20:23], s48 offen lds
    buffer_load_dwordx4 v10, s[20:23], s48 offen offset:1024 lds
    s_add_u32 s48, s48, s49
    s_waitcnt vmcnt(8)
    ds_read_b64_tr_b16 v[40:41], v12 offset:2048
    ds_read_b64_tr_b16 v[42:43], v12 offset:3072
    ds_read_b64_tr_b16 v[44:45], v12 offset:2304
    ds_read_b64_tr_b16 v[46:47], v12 offset:3328
    buffer_load_dwordx4 v[112:115], v8, s[12:15], s50 offen sc1
    buffer_load_dwordx4 v[116:119], v8, s[12:15], s50 offen offset:1024 sc1
    s_add_u32 s50, s50, 2048
    s_waitcnt vmcnt(24)
    v_mfma_f32_32x32x16_bf16 v[128:143], v[32:35], v[104:107], v[128:143]
    v_mfma_f32_32x32x16_bf16 v[144:159], v[32:35], v[108:111], v[144:159]
    v_mfma_f32_32x32x16_bf16 v[160:175], v[36:39], v[104:107], v[160:175]
    v_mfma_f32_32x32x16_bf16 v[176:191], v[36:39], v[108:111], v[176:191]
    s_waitcnt lgkmcnt(0)
    s_add_u32 m0, s46, 2048
    s_nop 0
    buffer_load_dwordx4 v9, s[20:23], s48 offen lds
    buffer_load_dwordx4 v10, s[20:23], s48 offen offset:1024 lds
    s_add_u32 s48, s48, s49
    s_waitcnt vmcnt(8)
    ds_read_b64_tr_b16 v[32:33], v12 offset:4096
    ds_read_b64_tr_b16 v[34:35], v12 offset:5120
    ds_read_b64_tr_b16 v[36:37], v12 offset:4352
    ds_read_b64_tr_b16 v[38:39], v12 offset:5376
    buffer_load_dwordx4 v[104:107], v8, s[12:15], s50 offen sc1
    buffer_load_dwordx4 v[108:111], v8, s[12:15], s50 offen offset:1024 sc1
    s_add_u32 s50, s50, 2048
    s_waitcnt vmcnt(24)
    v_mfma_f32_32x32x16_bf16 v[128:143], v[40:43], v[96:99], v[128:143]
    v_mfma_f32_32x32x16_bf16 v[144:159], v[40:43], v[100:103], v[144:159]
    v_mfma_f32_32x32x16_bf16 v[160:175], v[44:47], v[96:99], v[160:175]
    v_mfma_f32_32x32x16_bf16 v[176:191], v[44:47], v[100:103], v[176:191]
    s_waitcnt lgkmcnt(0)
    s_add_u32 m0, s46, 4096
    s_nop 0
    buffer_load_dwordx4 v9, s[20:23], s48 offen lds
    buffer_load_dwordx4 v10, s[20:23], s48 offen offset:1024 lds
    s_add_u32 s48, s48, s49
    s_waitcnt vmcnt(8)
    ds_read_b64_tr_b16 v[40:41], v12 offset:0
    ds_read_b64_tr_b16 v[42:43], v12 offset:1024
    ds_read_b64_tr_b16 v[44:45], v12 offset:256
    ds_read_b64_tr_b16 v[46:47], v12 offset:1280
    buffer_load_dwordx4 v[96:99], v8, s[12:15], s50 offen sc1
    buffer_load_dwordx4 v[100:103], v8, s[12:15], s50 offen offset:1024 sc1
    s_add_u32 s50, s50, 2048
    s_waitcnt vmcnt(24)
    v_mfma_f32_32x32x16_bf16 v[128:143], v[32:35], v[88:91], v[128:143]
    v_mfma_f32_32x32x16_bf16 v[144:159], v[32:35], v[92:95], v[144:159]
    v_mfma_f32_32x32x16_bf16 v[160:175], v[36:39], v[88:91], v[160:175]
    v_mfma_f32_32x32x16_bf16 v[176:191], v[36:39], v[92:95], v[176:191]
    s_waitcnt lgkmcnt(0)
    s_add_u32 m0, s46, 0
    s_nop 0
    buffer_load_dwordx4 v9, s[20:23], s48 offen lds
    buffer_load_dwordx4 v10, s[20:23], s48 offen offset:1024 lds
    s_add_u32 s48, s48, s49
    s_waitcnt vmcnt(8)
    ds_read_b64_tr_b16 v[32:33], v12 offset:2048
    ds_read_b64_tr_b16 v[34:35], v12 offset:3072
    ds_read_b64_tr_b16 v[36:37], v12 offset:2304
    ds_read_b64_tr_b16 v[38:39], v12 offset:3328
    buffer_load_dwordx4 v[88:91], v8, s[12:15], s50 offen sc1
    buffer_load_dwordx4 v[92:95], v8, s[12:15], s50 offen offset:1024 sc1
    s_add_u32 s50, s50, 2048
    s_waitcnt vmcnt(24)
    v_mfma_f32_32x32x16_bf16 v[128:143], v[40:43], v[80:83], v[128:143]
    v_mfma_f32_32x32x16_bf16 v[144:159], v[40:43], v[84:87], v[144:159]
    v_mfma_f32_32x32x16_bf16 v[160:175], v[44:47], v[80:83], v[160:175]
    v_mfma_f32_32x32x16_bf16 v[176:191], v[44:47], v[84:87], v[176:191]
    s_waitcnt lgkmcnt(0)
    s_add_u32 m0, s46, 2048
    s_nop 0
    buffer_load_dwordx4 v9, s[20:23], s48 offen lds
    buffer_load_dwordx4 v10, s[20:23], s48 offen offset:1024 lds
    s_add_u32 s48, s48, s49
    s_waitcnt vmcnt(8)
    ds_read_b64_tr_b16 v[40:41], v12 offset:4096
    ds_read_b64_tr_b16 v[42:43], v12 offset:5120
    ds_read_b64_tr_b16 v[44:45], v12 offset:4352
    ds_read_b64_tr_b16 v[46:47], v12 offset:5376
    buffer_load_dwordx4 v[80:83], v8, s[12:15], s50 offen sc1
    buffer_load_dwordx4 v[84:87], v8, s[12:15], s50 offen offset:1024 sc1
    s_add_u32 s50, s50, 2048
    s_waitcnt vmcnt(24)
    v_mfma_f32_32x32x16_bf16 v[128:143], v[32:35], v[72:75], v[128:143]
    v_mfma_f32_32x32x16_bf16 v[144:159], v[32:35], v[76:79], v[144:159]
    v_mfma_f32_32x32x16_bf16 v[160:175], v[36:39], v[72:75], v[160:175]
    v_mfma_f32_32x32x16_bf16 v[176:191], v[36:39], v[76:79], v[176:191]
    s_waitcnt lgkmcnt(0)
    s_add_u32 m0, s46, 4096
    s_nop 0
    buffer_load_dwordx4 v9, s[20:23], s48 offen lds
    buffer_load_dwordx4 v10, s[20:23], s48 offen offset:1024 lds
    s_add_u32 s48, s48, s49
    s_waitcnt vmcnt(8)
    ds_read_b64_tr_b16 v[32:33], v12 offset:0
    ds_read_b64_tr_b16 v[34:35], v12 offset:1024
    ds_read_b64_tr_b16 v[36:37], v12 offset:256
    ds_read_b64_tr_b16 v[38:39], v12 offset:1280
    buffer_load_dwordx4 v[72:75], v8, s[12:15], s50 offen sc1
    buffer_load_dwordx4 v[76:79], v8, s[12:15], s50 offen offset:1024 sc1
    s_add_u32 s50, s50, 2048
    s_waitcnt vmcnt(24)
    v_mfma_f32_32x32x16_bf16 v[128:143], v[40:43], v[120:123], v[128:143]
    v_mfma_f32_32x32x16_bf16 v[144:159], v[40:43], v[124:127], v[144:159]
    v_mfma_f32_32x32x16_bf16 v[160:175], v[44:47], v[120:123], v[160:175]
    v_mfma_f32_32x32x16_bf16 v[176:191], v[44:47], v[124:127], v[176:191]
    s_waitcnt lgkmcnt(0)
    s_add_u32 m0, s46, 0
    s_nop 0
    buffer_load_dwordx4 v9, s[20:23], s48 offen lds
    buffer_load_dwordx4 v10, s[20:23], s48 offen offset:1024 lds
    s_add_u32 s48, s48, s49
    buffer_load_dwordx4 v[16:19], v13, s[4:7], 0 offen
    s_lshl_b32 s60, s56, 14
    s_add_u32 s60, s60, s51
    s_add_u32 s60, s60, 229376
    s_add_u32 s61, s60, 4096
    s_add_u32 s62, s60, 8192
    s_add_u32 s63, s60, 12288
    s_lshl_b32 s44, s56, 2
    v_add_u32 v25, s44, v2
    s_mov_b32 s47, 32768
WC_33:
    ds_read_b32 v4, v25 offset:60
    s_waitcnt lgkmcnt(0)
    v_readfirstlane_b32 s43, v4
    s_sub_u32 s47, s47, 1
    s_cbranch_scc1 WD_34
    s_cmp_ge_u32 s43, 1
    s_cbranch_scc1 WD_34
    s_sleep 2
    s_branch WC_33
WD_34:
    s_setprio 3
    s_waitcnt vmcnt(9)
    ds_read_b64_tr_b16 v[40:41], v12 offset:2048
    ds_read_b64_tr_b16 v[42:43], v12 offset:3072
    ds_read_b64_tr_b16 v[44:45], v12 offset:2304
    ds_read_b64_tr_b16 v[46:47], v12 offset:3328
    s_waitcnt vmcnt(23)
    v_mfma_f32_32x32x16_bf16 v[128:143], v[32:35], v[112:115], v[128:143]
    v_mfma_f32_32x32x16_bf16 v[144:159], v[32:35], v[116:119], v[144:159]
    v_mfma_f32_32x32x16_bf16 v[160:175], v[36:39], v[112:115], v[160:175]
    v_mfma_f32_32x32x16_bf16 v[176:191], v[36:39], v[116:119], v[176:191]
    s_waitcnt lgkmcnt(0)
    s_add_u32 m0, s46, 2048
    s_nop 0
    buffer_load_dwordx4 v9, s[20:23], s48 offen lds
    buffer_load_dwordx4 v10, s[20:23], s48 offen offset:1024 lds
    s_add_u32 s48, s48, s49
    s_waitcnt vmcnt(7)
    ds_read_b64_tr_b16 v[32:33], v12 offset:4096
    ds_read_b64_tr_b16 v[34:35], v12 offset:5120
    ds_read_b64_tr_b16 v[36:37], v12 offset:4352
    ds_read_b64_tr_b16 v[38:39], v12 offset:5376
    s_waitcnt vmcnt(21)
    v_mfma_f32_32x32x16_bf16 v[128:143], v[40:43], v[104:107], v[128:143]
    v_mfma_f32_32x32x16_bf16 v[144:159], v[40:43], v[108:111], v[144:159]
    v_mfma_f32_32x32x16_bf16 v[160:175], v[44:47], v[104:107], v[160:175]
    v_mfma_f32_32x32x16_bf16 v[176:191], v[44:47], v[108:111], v[176:191]
    s_waitcnt lgkmcnt(0)
    s_add_u32 m0, s46, 4096
    s_nop 0
    buffer_load_dwordx4 v9, s[20:23], s48 offen lds
    buffer_load_dwordx4 v10, s[20:23], s48 offen offset:1024 lds
    s_add_u32 s48, s48, s49
    s_waitcnt vmcnt(5)
    ds_read_b64_tr_b16 v[40:41], v12 offset:0
    ds_read_b64_tr_b16 v[42:43], v12 offset:1024
    ds_read_b64_tr_b16 v[44:45], v12 offset:256
    ds_read_b64_tr_b16 v[46:47], v12 offset:1280
    s_waitcnt vmcnt(19)
    v_mfma_f32_32x32x16_bf16 v[128:143], v[32:35], v[96:99], v[128:143]
    v_mfma_f32_32x32x16_bf16 v[144:159], v[32:35], v[100:103], v[144:159]
    v_mfma_f32_32x32x16_bf16 v[160:175], v[36:39], v[96:99], v[160:175]
    v_mfma_f32_32x32x16_bf16 v[176:191], v[36:39], v[100:103], v[176:191]
    s_waitcnt lgkmcnt(0)
    s_waitcnt vmcnt(2)
    ds_read_b64_tr_b16 v[32:33], v12 offset:2048
    ds_read_b64_tr_b16 v[34:35], v12 offset:3072
    ds_read_b64_tr_b16 v[36:37], v12 offset:2304
    ds_read_b64_tr_b16 v[38:39], v12 offset:3328
    s_waitcnt vmcnt(15)
    v_mfma_f32_32x32x16_bf16 v[128:143], v[40:43], v[88:91], v[128:143]
    v_mfma_f32_32x32x16_bf16 v[144:159], v[40:43], v[92:95], v[144:159]
    v_mfma_f32_32x32x16_bf16 v[160:175], v[44:47], v[88:91], v[160:175]
    v_mfma_f32_32x32x16_bf16 v[176:191], v[44:47], v[92:95], v[176:191]
    s_waitcnt lgkmcnt(0)
    s_waitcnt vmcnt(0)
    ds_read_b64_tr_b16 v[40:41], v12 offset:4096
    ds_read_b64_tr_b16 v[42:43], v12 offset:5120
    ds_read_b64_tr_b16 v[44:45], v12 offset:4352
    ds_read_b64_tr_b16 v[46:47], v12 offset:5376
    s_waitcnt vmcnt(11)
    v_mfma_f32_32x32x16_bf16 v[128:143], v[32:35], v[80:83], v[128:143]
    v_mfma_f32_32x32x16_bf16 v[144:159], v[32:35], v[84:87], v[144:159]
    v_mfma_f32_32x32x16_bf16 v[160:175], v[36:39], v[80:83], v[160:175]
    v_mfma_f32_32x32x16_bf16 v[176:191], v[36:39], v[84:87], v[176:191]
    s_waitcnt lgkmcnt(0)
    s_waitcnt vmcnt(7)
    v_mfma_f32_32x32x16_bf16 v[128:143], v[40:43], v[72:75], v[128:143]
    v_mfma_f32_32x32x16_bf16 v[144:159], v[40:43], v[76:79], v[144:159]
    v_mfma_f32_32x32x16_bf16 v[160:175], v[44:47], v[72:75], v[160:175]
    v_mfma_f32_32x32x16_bf16 v[176:191], v[44:47], v[76:79], v[176:191]
L_G_SKIP:
    v_and_b32 v25, 31, v1
    v_mul_u32_u24 v25, 272, v25
    v_lshl_add_u32 v25, v24, 4, v25
    s_mul_i32 s43, s56, 17408
    v_add_u32 v25, s43, v25
    s_mov_b32 s47, 32768
WC_35:
    ds_read_b32 v4, v2 offset:40
    s_waitcnt lgkmcnt(0)
    v_readfirstlane_b32 s43, v4
    s_sub_u32 s47, s47, 1
    s_cbranch_scc1 WD_36
    s_cmp_ge_u32 s43, 4
    s_cbranch_scc1 WD_36
    s_sleep 1
    s_branch WC_35
WD_36:
    s_setprio 3
    s_mov_b32 s47, 32768
    buffer_load_dwordx4 v[32:35], v8, s[12:15], s60 offen offset:0 sc1
    buffer_load_dwordx4 v[36:39], v8, s[12:15], s60 offen offset:1024 sc1
    buffer_load_dwordx4 v[40:43], v8, s[12:15], s60 offen offset:2048 sc1
    buffer_load_dwordx4 v[44:47], v8, s[12:15], s60 offen offset:3072 sc1
    buffer_load_dwordx4 v[48:51], v8, s[12:15], s61 offen offset:0 sc1
    buffer_load_dwordx4 v[52:55], v8, s[12:15], s61 offen offset:1024 sc1
    buffer_load_dwordx4 v[56:59], v8, s[12:15], s61 offen offset:2048 sc1
    buffer_load_dwordx4 v[60:63], v8, s[12:15], s61 offen offset:3072 sc1
    buffer_load_dwordx4 v[64:67], v8, s[12:15], s62 offen offset:0 sc1
    buffer_load_dwordx4 v[68:71], v8, s[12:15], s62 offen offset:1024 sc1
    buffer_load_dwordx4 v[72:75], v8, s[12:15], s62 offen offset:2048 sc1
    buffer_load_dwordx4 v[76:79], v8, s[12:15], s62 offen offset:3072 sc1
    buffer_load_dwordx4 v[80:83], v8, s[12:15], s63 offen offset:0 sc1
    buffer_load_dwordx4 v[84:87], v8, s[12:15], s63 offen offset:1024 sc1
    buffer_load_dwordx4 v[88:91], v8, s[12:15], s63 offen offset:2048 sc1
    buffer_load_dwordx4 v[92:95], v8, s[12:15], s63 offen offset:3072 sc1
L_OW0:
    s_waitcnt vmcnt(12)
    v_max3_u32 v4, v32, v33, v34
    v_max3_u32 v5, v35, v36, v37
    v_max3_u32 v4, v4, v38, v39
    v_max3_u32 v5, v5, v40, v41
    v_max3_u32 v4, v4, v42, v43
    v_max3_u32 v5, v5, v44, v45
    v_max3_u32 v4, v4, v46, v47
    v_max_u32 v4, v4, v5
    v_cmp_eq_u32 vcc, -1, v4
    s_cmp_lg_u64 vcc, 0
    s_cbranch_scc1 L_OR0
L_OM0:
    v_mfma_f32_32x32x16_bf16 v[128:143], v[192:195], v[32:35], v[128:143]
    v_mfma_f32_32x32x16_bf16 v[144:159], v[192:195], v[36:39], v[144:159]
    v_mfma_f32_32x32x16_bf16 v[160:175], v[196:199], v[32:35], v[160:175]
    v_mfma_f32_32x32x16_bf16 v[176:191], v[196:199], v[36:39], v[176:191]
    v_mfma_f32_32x32x16_bf16 v[128:143], v[200:203], v[40:43], v[128:143]
    v_mfma_f32_32x32x16_bf16 v[144:159], v[200:203], v[44:47], v[144:159]
    v_mfma_f32_32x32x16_bf16 v[160:175], v[204:207], v[40:43], v[160:175]
    v_mfma_f32_32x32x16_bf16 v[176:191], v[204:207], v[44:47], v[176:191]
L_OW1:
    s_waitcnt vmcnt(8)
    v_max3_u32 v4, v48, v49, v50
    v_max3_u32 v5, v51, v52, v53
    v_max3_u32 v4, v4, v54, v55
    v_max3_u32 v5, v5, v56, v57
    v_max3_u32 v4, v4, v58, v59
    v_max3_u32 v5, v5, v60, v61
    v_max3_u32 v4, v4, v62, v63
    v_max_u32 v4, v4, v5
    v_cmp_eq_u32 vcc, -1, v4
    s_cmp_lg_u64 vcc, 0
    s_cbranch_scc1 L_OR1
L_OM1:
    v_mfma_f32_32x32x16_bf16 v[128:143], v[208:211], v[48:51], v[128:143]
    v_mfma_f32_32x32x16_bf16 v[144:159], v[208:211], v[52:55], v[144:159]
    v_mfma_f32_32x32x16_bf16 v[160:175], v[212:215], v[48:51], v[160:175]
    v_mfma_f32_32x32x16_bf16 v[176:191], v[212:215], v[52:55], v[176:191]
    v_mfma_f32_32x32x16_bf16 v[128:143], v[216:219], v[56:59], v[128:143]
    v_mfma_f32_32x32x16_bf16 v[144:159], v[216:219], v[60:63], v[144:159]
    v_mfma_f32_32x32x16_bf16 v[160:175], v[220:223], v[56:59], v[160:175]
    v_mfma_f32_32x32x16_bf16 v[176:191], v[220:223], v[60:63], v[176:191]
L_OW2:
    s_waitcnt vmcnt(4)
    v_max3_u32 v4, v64, v65, v66
    v_max3_u32 v5, v67, v68, v69
    v_max3_u32 v4, v4, v70, v71
    v_max3_u32 v5, v5, v72, v73
    v_max3_u32 v4, v4, v74, v75
    v_max3_u32 v5, v5, v76, v77
    v_max3_u32 v4, v4, v78, v79
    v_max_u32 v4, v4, v5
    v_cmp_eq_u32 vcc, -1, v4
    s_cmp_lg_u64 vcc, 0
    s_cbranch_scc1 L_OR2
L_OM2:
    v_mfma_f32_32x32x16_bf16 v[128:143], v[224:227], v[64:67], v[128:143]
    v_mfma_f32_32x32x16_bf16 v[144:159], v[224:227], v[68:71], v[144:159]
    v_mfma_f32_32x32x16_bf16 v[160:175], v[228:231], v[64:67], v[160:175]
    v_mfma_f32_32x32x16_bf16 v[176:191], v[228:231], v[68:71], v[176:191]
    v_mfma_f32_32x32x16_bf16 v[128:143], v[232:235], v[72:75], v[128:143]
    v_mfma_f32_32x32x16_bf16 v[144:159], v[232:235], v[76:79], v[144:159]
    v_mfma_f32_32x32x16_bf16 v[160:175], v[236:239], v[72:75], v[160:175]
    v_mfma_f32_32x32x16_bf16 v[176:191], v[236:239], v[76:79], v[176:191]
L_OW3:
    s_waitcnt vmcnt(0)
    v_max3_u32 v4, v80, v81, v82
    v_max3_u32 v5, v83, v84, v85
    v_max3_u32 v4, v4, v86, v87
    v_max3_u32 v5, v5, v88, v89
    v_max3_u32 v4, v4, v90, v91
    v_max3_u32 v5, v5, v92, v93
    v_max3_u32 v4, v4, v94, v95
    v_max_u32 v4, v4, v5
    v_cmp_eq_u32 vcc, -1, v4
    s_cmp_lg_u64 vcc, 0
    s_cbranch_scc1 L_OR3
L_OM3:
    v_mfma_f32_32x32x16_bf16 v[128:143], v[240:243], v[80:83], v[128:143]
    v_mfma_f32_32x32x16_bf16 v[144:159], v[240:243], v[84:87], v[144:159]
    v_mfma_f32_32x32x16_bf16 v[160:175], v[244:247], v[80:83], v[160:175]
    v_mfma_f32_32x32x16_bf16 v[176:191], v[244:247], v[84:87], v[176:191]
    v_mfma_f32_32x32x16_bf16 v[128:143], v[248:251], v[88:91], v[128:143]
    v_mfma_f32_32x32x16_bf16 v[144:159], v[248:251], v[92:95], v[144:159]
    v_mfma_f32_32x32x16_bf16 v[160:175], v[252:255], v[88:91], v[160:175]
    v_mfma_f32_32x32x16_bf16 v[176:191], v[252:255], v[92:95], v[176:191]
    s_nop 8
    ds_write_b128 v25, v[128:131] offset:0
    ds_write_b128 v25, v[132:135] offset:32
    ds_write_b128 v25, v[136:139] offset:64
    ds_write_b128 v25, v[140:143] offset:96
    ds_write_b128 v25, v[144:147] offset:8704
    ds_write_b128 v25, v[148:151] offset:8736
    ds_write_b128 v25, v[152:155] offset:8768
    ds_write_b128 v25, v[156:159] offset:8800
    ds_write_b128 v25, v[160:163] offset:128
    ds_write_b128 v25, v[164:167] offset:160
    ds_write_b128 v25, v[168:171] offset:192
    ds_write_b128 v25, v[172:175] offset:224
    ds_write_b128 v25, v[176:179] offset:8832
    ds_write_b128 v25, v[180:183] offset:8864
    ds_write_b128 v25, v[184:187] offset:8896
    ds_write_b128 v25, v[188:191] offset:8928
    s_waitcnt lgkmcnt(0)
L_FINAL:
    v_lshrrev_b32 v4, 3, v0
    v_and_b32 v5, 7, v0
    v_mul_u32_u24 v4, 272, v4
    v_lshl_add_u32 v4, v5, 5, v4
    s_waitcnt vmcnt(0)
    v_lshlrev_b32 v64, 16, v16
    v_and_b32 v65, 0xffff0000, v16
    v_lshlrev_b32 v66, 16, v17
    v_and_b32 v67, 0xffff0000, v17
    v_lshlrev_b32 v68, 16, v18
    v_and_b32 v69, 0xffff0000, v18
    v_lshlrev_b32 v70, 16, v19
    v_and_b32 v71, 0xffff0000, v19
    s_barrier
    ds_read_b128 v[32:35], v4 offset:0
    ds_read_b128 v[36:39], v4 offset:16
    ds_read_b128 v[40:43], v4 offset:17408
    ds_read_b128 v[44:47], v4 offset:17424
    ds_read_b128 v[48:51], v4 offset:34816
    ds_read_b128 v[52:55], v4 offset:34832
    ds_read_b128 v[56:59], v4 offset:52224
    ds_read_b128 v[60:63], v4 offset:52240
    s_waitcnt lgkmcnt(6)
    v_pk_add_f32 v[64:65], v[64:65], v[32:33]
    v_pk_add_f32 v[66:67], v[66:67], v[34:35]
    v_pk_add_f32 v[68:69], v[68:69], v[36:37]
    v_pk_add_f32 v[70:71], v[70:71], v[38:39]
    s_waitcnt lgkmcnt(4)
    v_pk_add_f32 v[64:65], v[64:65], v[40:41]
    v_pk_add_f32 v[66:67], v[66:67], v[42:43]
    v_pk_add_f32 v[68:69], v[68:69], v[44:45]
    v_pk_add_f32 v[70:71], v[70:71], v[46:47]
    s_waitcnt lgkmcnt(2)
    v_pk_add_f32 v[64:65], v[64:65], v[48:49]
    v_pk_add_f32 v[66:67], v[66:67], v[50:51]
    v_pk_add_f32 v[68:69], v[68:69], v[52:53]
    v_pk_add_f32 v[70:71], v[70:71], v[54:55]
    s_waitcnt lgkmcnt(0)
    v_pk_add_f32 v[64:65], v[64:65], v[56:57]
    v_pk_add_f32 v[66:67], v[66:67], v[58:59]
    v_pk_add_f32 v[68:69], v[68:69], v[60:61]
    v_pk_add_f32 v[70:71], v[70:71], v[62:63]
    v_cvt_pk_bf16_f32 v72, v64, v65
    v_cvt_pk_bf16_f32 v73, v66, v67
    v_cvt_pk_bf16_f32 v74, v68, v69
    v_cvt_pk_bf16_f32 v75, v70, v71
    buffer_store_dwordx4 v[72:75], v13, s[8:11], 0 offen sc1
L_END:
    s_endpgm
L_A_PRE:
    s_cmp_eq_u32 s97, 0
    s_cbranch_scc1 L_WQP
    s_setprio 2
L_WQP:
    s_lshl_b32 s43, s40, 13
    s_add_u32 m0, s43, 0
    s_nop 0
    buffer_load_dwordx4 v9, s[24:27], s48 offen lds
    buffer_load_dwordx4 v10, s[24:27], s48 offen offset:1024 lds
    s_add_u32 s48, s48, 16384
    s_add_u32 m0, m0, 2048
    s_nop 0
    buffer_load_dwordx4 v9, s[24:27], s48 offen lds
    buffer_load_dwordx4 v10, s[24:27], s48 offen offset:1024 lds
    s_add_u32 s48, s48, 16384
    s_add_u32 m0, m0, 2048
    s_nop 0
    buffer_load_dwordx4 v9, s[24:27], s48 offen lds
    buffer_load_dwordx4 v10, s[24:27], s48 offen offset:1024 lds
    s_add_u32 s48, s48, 16384
    s_add_u32 m0, m0, 2048
    s_nop 0
    buffer_load_dwordx4 v9, s[24:27], s48 offen lds
    buffer_load_dwordx4 v10, s[24:27], s48 offen offset:1024 lds
    s_add_u32 s48, s48, 212992
    s_add_u32 m0, m0, 26624
    s_nop 0
    buffer_load_dwordx4 v9, s[24:27], s48 offen lds
    buffer_load_dwordx4 v10, s[24:27], s48 offen offset:1024 lds
    s_add_u32 s48, s48, 16384
    s_add_u32 m0, m0, 2048
    s_nop 0
    buffer_load_dwordx4 v9, s[24:27], s48 offen lds
    buffer_load_dwordx4 v10, s[24:27], s48 offen offset:1024 lds
    s_add_u32 s48, s48, 16384
    s_add_u32 m0, m0, 2048
    s_nop 0
    buffer_load_dwordx4 v9, s[24:27], s48 offen lds
    buffer_load_dwordx4 v10, s[24:27], s48 offen offset:1024 lds
    s_add_u32 s48, s48, 16384
    s_add_u32 m0, m0, 2048
    s_nop 0
    buffer_load_dwordx4 v9, s[24:27], s48 offen lds
    buffer_load_dwordx4 v10, s[24:27], s48 offen offset:1024 lds
    s_mov_b32 s43, 1376256
    buffer_load_dword v210, v27, s[32:35], 0 offen
    buffer_load_dword v210, v27, s[32:35], s43 offen
    v_and_b32 v25, 31, v1
    s_and_b32 s43, s40, 1
    s_mul_i32 s43, s43, 33280
    s_add_u32 s43, s43, 67584
    v_mul_u32_u24 v11, 1040, v25
    v_lshl_add_u32 v11, v24, 4, v11
    v_add_u32 v11, s43, v11
    s_lshr_b32 s43, s40, 1
    s_lshl_b32 s43, s43, 8
    v_lshl_add_u32 v12, v24, 10, v23
    v_add_u32 v12, s43, v12
    s_mov_b32 s47, 32768
WC_37:
    ds_read_b32 v4, v2 offset:48
    s_waitcnt lgkmcnt(0)
    v_readfirstlane_b32 s43, v4
    s_sub_u32 s47, s47, 1
    s_cbranch_scc1 WD_38
    s_cmp_ge_u32 s43, 8
    s_cbranch_scc1 WD_38
    s_sleep 1
    s_branch WC_37
WD_38:
    s_cmp_lg_u32 s97, 0
    s_cbranch_scc1 L_XQ
    s_mov_b32 s47, 32768
WC_39:
    ds_read_b32 v4, v2 offset:16
    s_waitcnt lgkmcnt(0)
    v_readfirstlane_b32 s43, v4
    s_sub_u32 s47, s47, 1
    s_cbranch_scc1 WD_40
    s_cmp_ge_u32 s43, 4
    s_cbranch_scc1 WD_40
    s_sleep 1
    s_branch WC_39
WD_40:
L_XQ:
    ds_read_b128 v[32:35], v11 offset:0
    ds_read_b128 v[36:39], v11 offset:32
    ds_read_b128 v[40:43], v11 offset:64
    ds_read_b128 v[44:47], v11 offset:96
    ds_read_b128 v[48:51], v11 offset:128
    ds_read_b128 v[52:55], v11 offset:160
    ds_read_b128 v[56:59], v11 offset:192
    ds_read_b128 v[60:63], v11 offset:224
    s_waitcnt lgkmcnt(4)
    ds_read_b128 v[64:67], v11 offset:256
    ds_read_b128 v[68:71], v11 offset:288
    ds_read_b128 v[72:75], v11 offset:320
    ds_read_b128 v[76:79], v11 offset:352
    ds_read_b128 v[80:83], v11 offset:384
    ds_read_b128 v[84:87], v11 offset:416
    ds_read_b128 v[88:91], v11 offset:448
    ds_read_b128 v[92:95], v11 offset:480
    s_waitcnt lgkmcnt(4)
    ds_read_b128 v[96:99], v11 offset:512
    ds_read_b128 v[100:103], v11 offset:544
    ds_read_b128 v[104:107], v11 offset:576
    ds_read_b128 v[108:111], v11 offset:608
    ds_read_b128 v[112:115], v11 offset:640
    ds_read_b128 v[116:119], v11 offset:672
    ds_read_b128 v[120:123], v11 offset:704
    ds_read_b128 v[124:127], v11 offset:736
    s_waitcnt lgkmcnt(4)
    ds_read_b128 v[128:131], v11 offset:768
    ds_read_b128 v[132:135], v11 offset:800
    ds_read_b128 v[136:139], v11 offset:832
    ds_read_b128 v[140:143], v11 offset:864
    ds_read_b128 v[160:163], v11 offset:896
    ds_read_b128 v[164:167], v11 offset:928
    ds_read_b128 v[168:171], v11 offset:960
    ds_read_b128 v[172:175], v11 offset:992
    s_waitcnt vmcnt(10)
    s_setprio 2
    s_mov_b64 exec, 1
    ds_add_u32 v2, v3 offset:36
    s_mov_b64 exec, -1
    s_mov_b32 s47, 32768
WC_41:
    ds_read_b32 v4, v2 offset:36
    s_waitcnt lgkmcnt(0)
    v_readfirstlane_b32 s43, v4
    s_sub_u32 s47, s47, 1
    s_cbranch_scc1 WD_42
    s_cmp_ge_u32 s43, 4
    s_cbranch_scc1 WD_42
    s_branch WC_41
WD_42:
    ds_read_b64_tr_b16 v[176:177], v12 offset:0
    ds_read_b64_tr_b16 v[178:179], v12 offset:512
    ds_read_b64_tr_b16 v[180:181], v12 offset:2048
    ds_read_b64_tr_b16 v[182:183], v12 offset:2560
    ds_read_b64_tr_b16 v[184:185], v12 offset:4096
    ds_read_b64_tr_b16 v[186:187], v12 offset:4608
    ds_read_b64_tr_b16 v[188:189], v12 offset:6144
    ds_read_b64_tr_b16 v[190:191], v12 offset:6656
    ds_read_b64_tr_b16 v[192:193], v12 offset:8192
    ds_read_b64_tr_b16 v[194:195], v12 offset:8704
    ds_read_b64_tr_b16 v[196:197], v12 offset:10240
    ds_read_b64_tr_b16 v[198:199], v12 offset:10752
    ds_read_b64_tr_b16 v[200:201], v12 offset:12288
    ds_read_b64_tr_b16 v[202:203], v12 offset:12800
    s_waitcnt lgkmcnt(12)
    v_mfma_f32_32x32x16_bf16 v[144:159], v[176:179], v[32:35], 0
    ds_read_b64_tr_b16 v[204:205], v12 offset:14336
    ds_read_b64_tr_b16 v[206:207], v12 offset:14848
    s_waitcnt lgkmcnt(12)
    v_mfma_f32_32x32x16_bf16 v[144:159], v[180:183], v[36:39], v[144:159]
    ds_read_b64_tr_b16 v[176:177], v12 offset:16384
    ds_read_b64_tr_b16 v[178:179], v12 offset:16896
    s_waitcnt lgkmcnt(12)
    v_mfma_f32_32x32x16_bf16 v[144:159], v[184:187], v[40:43], v[144:159]
    ds_read_b64_tr_b16 v[180:181], v12 offset:18432
    ds_read_b64_tr_b16 v[182:183], v12 offset:18944
    s_waitcnt lgkmcnt(12)
    v_mfma_f32_32x32x16_bf16 v[144:159], v[188:191], v[44:47], v[144:159]
    ds_read_b64_tr_b16 v[184:185], v12 offset:20480
    ds_read_b64_tr_b16 v[186:187], v12 offset:20992
    s_waitcnt lgkmcnt(12)
    v_mfma_f32_32x32x16_bf16 v[144:159], v[192:195], v[48:51], v[144:159]
    ds_read_b64_tr_b16 v[188:189], v12 offset:22528
    ds_read_b64_tr_b16 v[190:191], v12 offset:23040
    s_waitcnt lgkmcnt(12)
    v_mfma_f32_32x32x16_bf16 v[144:159], v[196:199], v[52:55], v[144:159]
    ds_read_b64_tr_b16 v[192:193], v12 offset:24576
    ds_read_b64_tr_b16 v[194:195], v12 offset:25088
    s_waitcnt lgkmcnt(12)
    v_mfma_f32_32x32x16_bf16 v[144:159], v[200:203], v[56:59], v[144:159]
    ds_read_b64_tr_b16 v[196:197], v12 offset:26624
    ds_read_b64_tr_b16 v[198:199], v12 offset:27136
    s_waitcnt lgkmcnt(12)
    v_mfma_f32_32x32x16_bf16 v[144:159], v[204:207], v[60:63], v[144:159]
    ds_read_b64_tr_b16 v[200:201], v12 offset:28672
    ds_read_b64_tr_b16 v[202:203], v12 offset:29184
    s_waitcnt lgkmcnt(12)
    v_mfma_f32_32x32x16_bf16 v[144:159], v[176:179], v[64:67], v[144:159]
    ds_read_b64_tr_b16 v[204:205], v12 offset:30720
    ds_read_b64_tr_b16 v[206:207], v12 offset:31232
    s_waitcnt lgkmcnt(12)
    v_mfma_f32_32x32x16_bf16 v[144:159], v[180:183], v[68:71], v[144:159]
    s_waitcnt vmcnt(2)
    s_mov_b64 exec, 1
    ds_add_u32 v2, v3 offset:52
    s_mov_b64 exec, -1
    s_mov_b32 s47, 32768
WC_43:
    ds_read_b32 v4, v2 offset:52
    s_waitcnt lgkmcnt(0)
    v_readfirstlane_b32 s43, v4
    s_sub_u32 s47, s47, 1
    s_cbranch_scc1 WD_44
    s_cmp_ge_u32 s43, 4
    s_cbranch_scc1 WD_44
    s_branch WC_43
WD_44:
    ds_read_b64_tr_b16 v[176:177], v12 offset:32768
    ds_read_b64_tr_b16 v[178:179], v12 offset:33280
    s_waitcnt lgkmcnt(12)
    v_mfma_f32_32x32x16_bf16 v[144:159], v[184:187], v[72:75], v[144:159]
    ds_read_b64_tr_b16 v[180:181], v12 offset:34816
    ds_read_b64_tr_b16 v[182:183], v12 offset:35328
    s_waitcnt lgkmcnt(12)
    v_mfma_f32_32x32x16_bf16 v[144:159], v[188:191], v[76:79], v[144:159]
    ds_read_b64_tr_b16 v[184:185], v12 offset:36864
    ds_read_b64_tr_b16 v[186:187], v12 offset:37376
    s_waitcnt lgkmcnt(12)
    v_mfma_f32_32x32x16_bf16 v[144:159], v[192:195], v[80:83], v[144:159]
    ds_read_b64_tr_b16 v[188:189], v12 offset:38912
    ds_read_b64_tr_b16 v[190:191], v12 offset:39424
    s_waitcnt lgkmcnt(12)
    v_mfma_f32_32x32x16_bf16 v[144:159], v[196:199], v[84:87], v[144:159]
    ds_read_b64_tr_b16 v[192:193], v12 offset:40960
    ds_read_b64_tr_b16 v[194:195], v12 offset:41472
    s_waitcnt lgkmcnt(12)
    v_mfma_f32_32x32x16_bf16 v[144:159], v[200:203], v[88:91], v[144:159]
    ds_read_b64_tr_b16 v[196:197], v12 offset:43008
    ds_read_b64_tr_b16 v[198:199], v12 offset:43520
    s_waitcnt lgkmcnt(12)
    v_mfma_f32_32x32x16_bf16 v[144:159], v[204:207], v[92:95], v[144:159]
    ds_read_b64_tr_b16 v[200:201], v12 offset:45056
    ds_read_b64_tr_b16 v[202:203], v12 offset:45568
    s_waitcnt lgkmcnt(12)
    v_mfma_f32_32x32x16_bf16 v[144:159], v[176:179], v[96:99], v[144:159]
    ds_read_b64_tr_b16 v[204:205], v12 offset:47104
    ds_read_b64_tr_b16 v[206:207], v12 offset:47616
    s_waitcnt lgkmcnt(12)
    v_mfma_f32_32x32x16_bf16 v[144:159], v[180:183], v[100:103], v[144:159]
    ds_read_b64_tr_b16 v[176:177], v12 offset:49152
    ds_read_b64_tr_b16 v[178:179], v12 offset:49664
    s_waitcnt lgkmcnt(12)
    v_mfma_f32_32x32x16_bf16 v[144:159], v[184:187], v[104:107], v[144:159]
    ds_read_b64_tr_b16 v[180:181], v12 offset:51200
    ds_read_b64_tr_b16 v[182:183], v12 offset:51712
    s_waitcnt lgkmcnt(12)
    v_mfma_f32_32x32x16_bf16 v[144:159], v[188:191], v[108:111], v[144:159]
    ds_read_b64_tr_b16 v[184:185], v12 offset:53248
    ds_read_b64_tr_b16 v[186:187], v12 offset:53760
    s_waitcnt lgkmcnt(12)
    v_mfma_f32_32x32x16_bf16 v[144:159], v[192:195], v[112:115], v[144:159]
    ds_read_b64_tr_b16 v[188:189], v12 offset:55296
    ds_read_b64_tr_b16 v[190:191], v12 offset:55808
    s_waitcnt lgkmcnt(12)
    v_mfma_f32_32x32x16_bf16 v[144:159], v[196:199], v[116:119], v[144:159]
    ds_read_b64_tr_b16 v[192:193], v12 offset:57344
    ds_read_b64_tr_b16 v[194:195], v12 offset:57856
    s_waitcnt lgkmcnt(12)
    v_mfma_f32_32x32x16_bf16 v[144:159], v[200:203], v[120:123], v[144:159]
    ds_read_b64_tr_b16 v[196:197], v12 offset:59392
    ds_read_b64_tr_b16 v[198:199], v12 offset:59904
    s_waitcnt lgkmcnt(12)
    v_mfma_f32_32x32x16_bf16 v[144:159], v[204:207], v[124:127], v[144:159]
    ds_read_b64_tr_b16 v[200:201], v12 offset:61440
    ds_read_b64_tr_b16 v[202:203], v12 offset:61952
    s_waitcnt lgkmcnt(12)
    v_mfma_f32_32x32x16_bf16 v[144:159], v[176:179], v[128:131], v[144:159]
    ds_read_b64_tr_b16 v[204:205], v12 offset:63488
    ds_read_b64_tr_b16 v[206:207], v12 offset:64000
    s_waitcnt lgkmcnt(12)
    v_mfma_f32_32x32x16_bf16 v[144:159], v[180:183], v[132:135], v[144:159]
    s_waitcnt lgkmcnt(10)
    v_mfma_f32_32x32x16_bf16 v[144:159], v[184:187], v[136:139], v[144:159]
    s_waitcnt lgkmcnt(8)
    v_mfma_f32_32x32x16_bf16 v[144:159], v[188:191], v[140:143], v[144:159]
    s_waitcnt lgkmcnt(6)
    v_mfma_f32_32x32x16_bf16 v[144:159], v[192:195], v[160:163], v[144:159]
    s_waitcnt lgkmcnt(4)
    v_mfma_f32_32x32x16_bf16 v[144:159], v[196:199], v[164:167], v[144:159]
    s_waitcnt lgkmcnt(2)
    v_mfma_f32_32x32x16_bf16 v[144:159], v[200:203], v[168:171], v[144:159]
    s_waitcnt lgkmcnt(0)
    v_mfma_f32_32x32x16_bf16 v[144:159], v[204:207], v[172:175], v[144:159]
    s_mov_b64 exec, 1
    ds_add_u32 v2, v3 offset:24
    s_mov_b64 exec, -1
    s_mov_b32 s47, 32768
GN_45:
    v_readfirstlane_b32 s100, v14
    s_sub_u32 s47, s47, 1
    s_cbranch_scc1 GD_46
    s_cmp_lg_u32 s100, 0
    s_cbranch_scc1 GD_46
    buffer_load_dword v14, v15, s[36:39], 0 offen sc1
    s_waitcnt vmcnt(0)
    s_branch GN_45
GD_46:
    s_mov_b32 s101, s100
    s_mov_b32 s50, 262144
    s_buffer_load_dword s24, s[12:15], s50 offset:0
    s_buffer_load_dword s25, s[12:15], s50 offset:128
    s_buffer_load_dword s26, s[12:15], s50 offset:256
    s_buffer_load_dword s27, s[12:15], s50 offset:384
    s_buffer_load_dword s28, s[12:15], s50 offset:512
    s_buffer_load_dword s29, s[12:15], s50 offset:640
    s_buffer_load_dword s30, s[12:15], s50 offset:768
    s_buffer_load_dword s31, s[12:15], s50 offset:896
    s_buffer_load_dword s32, s[12:15], s50 offset:1024
    s_buffer_load_dword s33, s[12:15], s50 offset:1152
    s_buffer_load_dword s34, s[12:15], s50 offset:1280
    s_buffer_load_dword s35, s[12:15], s50 offset:1408
    s_buffer_load_dword s36, s[12:15], s50 offset:1536
    s_buffer_load_dword s37, s[12:15], s50 offset:1664
    s_buffer_load_dword s38, s[12:15], s50 offset:1792
    s_buffer_load_dword s39, s[12:15], s50 offset:1920
    s_add_u32 s50, s50, 8192
    s_mov_b32 s43, 0x3eb8aa3b
    v_mul_f32 v144, s43, v144
    v_mul_f32 v145, s43, v145
    v_mul_f32 v146, s43, v146
    v_mul_f32 v147, s43, v147
    v_mul_f32 v148, s43, v148
    v_mul_f32 v149, s43, v149
    v_mul_f32 v150, s43, v150
    v_mul_f32 v151, s43, v151
    v_mul_f32 v152, s43, v152
    v_mul_f32 v153, s43, v153
    v_mul_f32 v154, s43, v154
    v_mul_f32 v155, s43, v155
    v_mul_f32 v156, s43, v156
    v_mul_f32 v157, s43, v157
    v_mul_f32 v158, s43, v158
    v_mul_f32 v159, s43, v159
    v_cvt_pk_bf16_f32 v24, v144, v145
    v_cvt_pk_bf16_f32 v25, v146, v147
    v_cvt_pk_bf16_f32 v26, v148, v149
    v_cvt_pk_bf16_f32 v27, v150, v151
    v_cvt_pk_bf16_f32 v28, v152, v153
    v_cvt_pk_bf16_f32 v29, v154, v155
    v_cvt_pk_bf16_f32 v30, v156, v157
    v_cvt_pk_bf16_f32 v31, v158, v159
    v_mov_b32 v184, 0xdddddddd
    v_mov_b32 v185, v8
    v_and_b32 v4, 31, v1
    v_lshrrev_b32 v5, 5, v1
    v_lshlrev_b32 v5, 8, v5
    v_lshl_add_u32 v5, v4, 4, v5
    v_mov_b32 v6, 528
    v_mov_b32 v7, 512
    v_and_b32 v186, 0x1b, v4
    v_cmp_eq_u32 vcc, 16, v186
    s_nop 1
    v_cndmask_b32 v6, v6, v7, vcc
    v_cmp_gt_u32 vcc, 16, v4
    s_nop 1
    v_cndmask_b32 v186, v6, v5, vcc
    v_add_u32 v186, 1024, v186
    s_mov_b32 s53, 0
    s_lshl_b32 s43, s42, 13
    s_lshr_b32 s44, s40, 1
    s_lshl_b32 s44, s44, 12
    s_add_u32 s43, s43, s44
    s_and_b32 s44, s40, 1
    s_lshl_b32 s44, s44, 10
    s_add_u32 s43, s43, s44
    s_add_u32 s43, s43, s51
    s_add_u32 s59, s43, 229376
    s_lshl_b32 s43, s40, 2
    v_add_u32 v187, s43, v2
    v_mov_b32 v188, v2
    s_mov_b32 s49, 4
    v_mov_b64 v[128:129], 0
    v_mov_b64 v[144:145], 0
    v_mov_b64 v[80:81], 0
    v_mov_b64 v[130:131], 0
    v_mov_b64 v[146:147], 0
    v_mov_b64 v[82:83], 0
    v_mov_b64 v[132:133], 0
    v_mov_b64 v[148:149], 0
    v_mov_b64 v[84:85], 0
    v_mov_b64 v[134:135], 0
    v_mov_b64 v[150:151], 0
    v_mov_b64 v[86:87], 0
    v_mov_b64 v[136:137], 0
    v_mov_b64 v[152:153], 0
    v_mov_b64 v[88:89], 0
    v_mov_b64 v[138:139], 0
    v_mov_b64 v[154:155], 0
    v_mov_b64 v[90:91], 0
    v_mov_b64 v[140:141], 0
    v_mov_b64 v[156:157], 0
    v_mov_b64 v[92:93], 0
    v_mov_b64 v[142:143], 0
    v_mov_b64 v[158:159], 0
    v_mov_b64 v[94:95], 0
    v_mov_b64 v[176:177], 0
    v_mov_b64 v[178:179], 0
    v_mov_b64 v[180:181], 0
    v_mov_b64 v[182:183], 0
    s_mov_b32 s47, 32768
WC_47:
    ds_read_b32 v4, v2 offset:24
    s_waitcnt lgkmcnt(0)
    v_readfirstlane_b32 s43, v4
    s_sub_u32 s47, s47, 1
    s_cbranch_scc1 WD_48
    s_cmp_ge_u32 s43, 4
    s_cbranch_scc1 WD_48
    s_branch WC_47
WD_48:
    s_setprio 0
    s_mov_b32 s47, 14
    s_branch PC_52
PF_49:
    s_buffer_load_dword s24, s[12:15], s50 offset:0
    s_buffer_load_dword s25, s[12:15], s50 offset:128
    s_buffer_load_dword s26, s[12:15], s50 offset:256
    s_buffer_load_dword s27, s[12:15], s50 offset:384
    s_buffer_load_dword s28, s[12:15], s50 offset:512
    s_buffer_load_dword s29, s[12:15], s50 offset:640
    s_buffer_load_dword s30, s[12:15], s50 offset:768
    s_buffer_load_dword s31, s[12:15], s50 offset:896
    s_buffer_load_dword s32, s[12:15], s50 offset:1024
    s_buffer_load_dword s33, s[12:15], s50 offset:1152
    s_buffer_load_dword s34, s[12:15], s50 offset:1280
    s_buffer_load_dword s35, s[12:15], s50 offset:1408
    s_buffer_load_dword s36, s[12:15], s50 offset:1536
    s_buffer_load_dword s37, s[12:15], s50 offset:1664
    s_buffer_load_dword s38, s[12:15], s50 offset:1792
    s_buffer_load_dword s39, s[12:15], s50 offset:1920
    s_add_u32 s50, s50, 8192
PC_52:
    s_waitcnt lgkmcnt(0)
    s_xor_b64 s[54:55], s[24:25], s[100:101]
    s_xor_b64 s[26:27], s[26:27], s[100:101]
    s_or_b64 s[54:55], s[54:55], s[26:27]
    s_xor_b64 s[28:29], s[28:29], s[100:101]
    s_or_b64 s[54:55], s[54:55], s[28:29]
    s_xor_b64 s[30:31], s[30:31], s[100:101]
    s_or_b64 s[54:55], s[54:55], s[30:31]
    s_xor_b64 s[32:33], s[32:33], s[100:101]
    s_or_b64 s[54:55], s[54:55], s[32:33]
    s_xor_b64 s[34:35], s[34:35], s[100:101]
    s_or_b64 s[54:55], s[54:55], s[34:35]
    s_xor_b64 s[36:37], s[36:37], s[100:101]
    s_or_b64 s[54:55], s[54:55], s[36:37]
    s_xor_b64 s[38:39], s[38:39], s[100:101]
    s_or_b64 s[54:55], s[54:55], s[38:39]
    s_cbranch_scc0 PD_50
    s_sleep 1
    s_sub_u32 s47, s47, 1
    s_cbranch_scc0 PF_49
    v_min_u32 v5, 15, v1
    v_lshlrev_b32 v5, 7, v5
    s_mov_b32 s47, 32768
PV_51:
    buffer_load_dword v4, v5, s[12:15], s50 offen sc1
    s_waitcnt vmcnt(0)
    v_cmp_eq_u32 vcc, s100, v4
    s_sub_u32 s47, s47, 1
    s_cbranch_scc1 PD_50
    s_cmp_eq_u64 vcc, -1
    s_cbranch_scc1 PD_50
    s_sleep 4
    s_branch PV_51
PD_50:
    s_setprio 3
    buffer_load_dwordx4 v[160:163], v8, s[12:15], 0 offen sc1
    s_mov_b32 s43, 2112
    buffer_load_dwordx4 v[164:167], v8, s[12:15], s43 offen sc1
    s_lshl_b32 s43, s40, 12
    s_add_u32 s48, s43, 0
    s_add_u32 m0, s43, 0
    s_nop 0
    buffer_load_dwordx4 v8, s[12:15], s48 offen offset:0 sc1 lds
    buffer_load_dwordx4 v8, s[12:15], s48 offen offset:1024 sc1 lds
    buffer_load_dwordx4 v8, s[12:15], s48 offen offset:2048 sc1 lds
    buffer_load_dwordx4 v8, s[12:15], s48 offen offset:3072 sc1 lds
    s_mov_b32 s44, 264192
    s_buffer_load_dword s24, s[12:15], s44 offset:0
    s_buffer_load_dword s25, s[12:15], s44 offset:128
    s_buffer_load_dword s26, s[12:15], s44 offset:256
    s_buffer_load_dword s27, s[12:15], s44 offset:384
    s_buffer_load_dword s28, s[12:15], s44 offset:512
    s_buffer_load_dword s29, s[12:15], s44 offset:640
    s_buffer_load_dword s30, s[12:15], s44 offset:768
    s_buffer_load_dword s31, s[12:15], s44 offset:896
    s_buffer_load_dword s32, s[12:15], s44 offset:1024
    s_buffer_load_dword s33, s[12:15], s44 offset:1152
    s_buffer_load_dword s34, s[12:15], s44 offset:1280
    s_buffer_load_dword s35, s[12:15], s44 offset:1408
    s_buffer_load_dword s36, s[12:15], s44 offset:1536
    s_buffer_load_dword s37, s[12:15], s44 offset:1664
    s_buffer_load_dword s38, s[12:15], s44 offset:1792
    s_buffer_load_dword s39, s[12:15], s44 offset:1920
    s_add_u32 s44, s44, 8192
    s_waitcnt vmcnt(4)
    v_mfma_f32_32x32x16_bf16 v[32:47], v[160:163], v[24:27], 0
    v_mfma_f32_32x32x16_bf16 v[64:79], v[160:163], v[28:31], 0
    s_nop 8
    v_mfma_f32_32x32x16_bf16 v[48:63], v[164:167], v[24:27], 0
    v_mfma_f32_32x32x16_bf16 v[212:227], v[164:167], v[28:31], 0
    v_max3_f32 v190, v32, v33, v34
    v_max3_f32 v190, v190, v35, v36
    v_max3_f32 v190, v190, v37, v38
    v_max3_f32 v190, v190, v39, v40
    v_max3_f32 v190, v190, v41, v42
    v_max3_f32 v190, v190, v43, v44
    v_max3_f32 v190, v190, v45, v46
    v_max_f32 v190, v190, v47
    v_max3_f32 v191, v64, v65, v66
    v_max3_f32 v191, v191, v67, v68
    v_max3_f32 v191, v191, v69, v70
    v_max3_f32 v191, v191, v71, v72
    v_max3_f32 v191, v191, v73, v74
    v_max3_f32 v191, v191, v75, v76
    v_max3_f32 v191, v191, v77, v78
    v_max_f32 v191, v191, v79
    v_max3_f32 v190, v190, v48, v49
    v_max3_f32 v190, v190, v50, v51
    v_max3_f32 v190, v190, v52, v53
    v_max3_f32 v190, v190, v54, v55
    v_max3_f32 v190, v190, v56, v57
    v_max3_f32 v190, v190, v58, v59
    v_max3_f32 v190, v190, v60, v61
    v_max3_f32 v190, v190, v62, v63
    v_max3_f32 v191, v191, v212, v213
    v_max3_f32 v191, v191, v214, v215
    v_max3_f32 v191, v191, v216, v217
    v_max3_f32 v191, v191, v218, v219
    v_max3_f32 v191, v191, v220, v221
    v_max3_f32 v191, v191, v222, v223
    v_max3_f32 v191, v191, v224, v225
    v_max3_f32 v191, v191, v226, v227
    v_mov_b32 v6, v190
    s_nop 1
    v_permlane32_swap_b32 v190, v6
    s_nop 1
    v_max_f32 v190, v190, v6
    v_mov_b32 v6, v191
    s_nop 1
    v_permlane32_swap_b32 v191, v6
    s_nop 1
    v_max_f32 v191, v191, v6
    v_add_f32 v4, 0x42d00000, v190
    v_add_f32 v5, 0x42d00000, v191
L_ATT_START:
    v_sub_f32 v96, 0, v4
    v_sub_f32 v97, 0, v4
    v_sub_f32 v112, 0, v5
    v_sub_f32 v113, 0, v5
    v_mov_b64 v[98:99], v[96:97]
    v_mov_b64 v[100:101], v[96:97]
    v_mov_b64 v[102:103], v[96:97]
    v_mov_b64 v[104:105], v[96:97]
    v_mov_b64 v[106:107], v[96:97]
    v_mov_b64 v[108:109], v[96:97]
    v_mov_b64 v[110:111], v[96:97]
    s_mov_b32 s50, s53
    s_cmp_lg_u32 s53, 0
    v_mfma_f32_32x32x16_bf16 v[32:47], v[160:163], v[24:27], v[96:111]
    v_mov_b64 v[114:115], v[112:113]
    v_mov_b64 v[116:117], v[112:113]
    v_mov_b64 v[118:119], v[112:113]
    v_mov_b64 v[120:121], v[112:113]
    v_mov_b64 v[122:123], v[112:113]
    v_mov_b64 v[124:125], v[112:113]
    v_mov_b64 v[126:127], v[112:113]
    s_cbranch_scc1 L_ATT_GO
    s_waitcnt vmcnt(0)
    s_mov_b32 s47, 14
    s_branch PC_56
PF_53:
    s_buffer_load_dword s24, s[12:15], s44 offset:0
    s_buffer_load_dword s25, s[12:15], s44 offset:128
    s_buffer_load_dword s26, s[12:15], s44 offset:256
    s_buffer_load_dword s27, s[12:15], s44 offset:384
    s_buffer_load_dword s28, s[12:15], s44 offset:512
    s_buffer_load_dword s29, s[12:15], s44 offset:640
    s_buffer_load_dword s30, s[12:15], s44 offset:768
    s_buffer_load_dword s31, s[12:15], s44 offset:896
    s_buffer_load_dword s32, s[12:15], s44 offset:1024
    s_buffer_load_dword s33, s[12:15], s44 offset:1152
    s_buffer_load_dword s34, s[12:15], s44 offset:1280
    s_buffer_load_dword s35, s[12:15], s44 offset:1408
    s_buffer_load_dword s36, s[12:15], s44 offset:1536
    s_buffer_load_dword s37, s[12:15], s44 offset:1664
    s_buffer_load_dword s38, s[12:15], s44 offset:1792
    s_buffer_load_dword s39, s[12:15], s44 offset:1920
    s_add_u32 s44, s44, 8192
PC_56:
    s_waitcnt lgkmcnt(0)
    s_xor_b64 s[54:55], s[24:25], s[100:101]
    s_xor_b64 s[26:27], s[26:27], s[100:101]
    s_or_b64 s[54:55], s[54:55], s[26:27]
    s_xor_b64 s[28:29], s[28:29], s[100:101]
    s_or_b64 s[54:55], s[54:55], s[28:29]
    s_xor_b64 s[30:31], s[30:31], s[100:101]
    s_or_b64 s[54:55], s[54:55], s[30:31]
    s_xor_b64 s[32:33], s[32:33], s[100:101]
    s_or_b64 s[54:55], s[54:55], s[32:33]
    s_xor_b64 s[34:35], s[34:35], s[100:101]
    s_or_b64 s[54:55], s[54:55], s[34:35]
    s_xor_b64 s[36:37], s[36:37], s[100:101]
    s_or_b64 s[54:55], s[54:55], s[36:37]
    s_xor_b64 s[38:39], s[38:39], s[100:101]
    s_or_b64 s[54:55], s[54:55], s[38:39]
    s_cbranch_scc0 PD_54
    s_sleep 1
    s_sub_u32 s47, s47, 1
    s_cbranch_scc0 PF_53
    v_min_u32 v5, 15, v1
    v_lshlrev_b32 v5, 7, v5
    s_mov_b32 s47, 32768
PV_55:
    buffer_load_dword v4, v5, s[12:15], s44 offen sc1
    s_waitcnt vmcnt(0)
    v_cmp_eq_u32 vcc, s100, v4
    s_sub_u32 s47, s47, 1
    s_cbranch_scc1 PD_54
    s_cmp_eq_u64 vcc, -1
    s_cbranch_scc1 PD_54
    s_sleep 4
    s_branch PV_55
PD_54:
    s_mov_b64 exec, 1
    ds_add_u32 v2, v3 offset:28
    s_mov_b64 exec, -1
    s_lshl_b32 s43, s40, 12
    s_add_u32 s48, s43, 16384
    s_add_u32 m0, s43, 16384
    s_nop 0
    buffer_load_dwordx4 v8, s[12:15], s48 offen offset:0 sc1 lds
    buffer_load_dwordx4 v8, s[12:15], s48 offen offset:1024 sc1 lds
    buffer_load_dwordx4 v8, s[12:15], s48 offen offset:2048 sc1 lds
    buffer_load_dwordx4 v8, s[12:15], s48 offen offset:3072 sc1 lds
    s_add_u32 s48, s48, 16384
    s_add_u32 m0, m0, 16384
    s_cmp_lg_u32 s40, 0
    s_cbranch_scc1 KD_57
    buffer_load_dwordx4 v8, s[12:15], s48 offen sc1 lds
KD_57:
    s_mov_b32 s47, 32768
WC_58:
    ds_read_b32 v4, v2 offset:28
    s_waitcnt lgkmcnt(0)
    v_readfirstlane_b32 s43, v4
    s_sub_u32 s47, s47, 1
    s_cbranch_scc1 WD_59
    s_cmp_ge_u32 s43, 4
    s_cbranch_scc1 WD_59
    s_branch WC_58
WD_59:
L_ATT_GO:
    s_setprio 1
    s_nop 1
    .p2align 6
L_ATT:
    v_mfma_f32_32x32x16_bf16 v[64:79], v[160:163], v[28:31], v[112:127]
    ds_read_b128 v[164:167], v185 offset:2112
    ds_read_b128 v[168:171], v186 offset:0
    ds_read_b128 v[172:175], v186 offset:544
    v_exp_f32 v48, v32
    v_exp_f32 v49, v33
    v_exp_f32 v50, v34
    v_exp_f32 v51, v35
    v_smfmac_f32_32x32x32_bf16 v[144:159], v[176:179], v[80:87], v184
    v_exp_f32 v52, v36
    v_exp_f32 v53, v37
    v_exp_f32 v54, v38
    v_exp_f32 v55, v39
    v_exp_f32 v56, v40
    v_exp_f32 v57, v41
    v_smfmac_f32_32x32x32_bf16 v[144:159], v[180:183], v[88:95], v184
    s_waitcnt lgkmcnt(0)
    v_exp_f32_e64 v58, v42
    v_exp_f32 v59, v43
    v_exp_f32 v60, v44
    v_exp_f32 v61, v45
    v_exp_f32 v62, v46
    v_exp_f32 v63, v47
    v_mfma_f32_32x32x16_bf16 v[32:47], v[164:167], v[24:27], v[96:111]
    v_exp_f32 v80, v64
    v_exp_f32 v81, v65
    v_exp_f32 v82, v66
    v_exp_f32 v83, v67
    v_smfmac_f32_32x32x32_bf16 v[128:143], v[168:171], v[48:55], v184
    v_exp_f32 v84, v68
    v_exp_f32 v85, v69
    v_exp_f32 v86, v70
    v_exp_f32 v87, v71
    v_exp_f32 v88, v72
    v_exp_f32 v89, v73
    v_smfmac_f32_32x32x32_bf16 v[128:143], v[172:175], v[56:63], v184
    v_exp_f32 v90, v74
    v_exp_f32 v91, v75
    v_exp_f32 v92, v76
    v_exp_f32 v93, v77
    v_exp_f32 v94, v78
    v_exp_f32 v95, v79
    v_mfma_f32_32x32x16_bf16 v[64:79], v[164:167], v[28:31], v[112:127]
    ds_read_b128 v[160:163], v185 offset:4224
    ds_read_b128 v[176:179], v186 offset:2112
    ds_read_b128 v[180:183], v186 offset:2656
    v_exp_f32 v48, v32
    v_exp_f32 v49, v33
    v_exp_f32 v50, v34
    v_exp_f32 v51, v35
    v_smfmac_f32_32x32x32_bf16 v[144:159], v[168:171], v[80:87], v184
    v_exp_f32 v52, v36
    v_exp_f32 v53, v37
    v_exp_f32 v54, v38
    v_exp_f32 v55, v39
    v_exp_f32 v56, v40
    v_exp_f32 v57, v41
    v_smfmac_f32_32x32x32_bf16 v[144:159], v[172:175], v[88:95], v184
    s_waitcnt lgkmcnt(0)
    v_exp_f32_e64 v58, v42
    v_exp_f32 v59, v43
    v_exp_f32 v60, v44
    v_exp_f32 v61, v45
    v_exp_f32 v62, v46
    v_exp_f32 v63, v47
    v_mfma_f32_32x32x16_bf16 v[32:47], v[160:163], v[24:27], v[96:111]
    v_exp_f32 v80, v64
    v_exp_f32 v81, v65
    v_exp_f32 v82, v66
    v_exp_f32 v83, v67
    v_smfmac_f32_32x32x32_bf16 v[128:143], v[176:179], v[48:55], v184
    v_exp_f32 v84, v68
    v_exp_f32 v85, v69
    v_exp_f32 v86, v70
    v_exp_f32 v87, v71
    v_exp_f32 v88, v72
    v_exp_f32 v89, v73
    v_smfmac_f32_32x32x32_bf16 v[128:143], v[180:183], v[56:63], v184
    v_exp_f32 v90, v74
    v_exp_f32 v91, v75
    v_exp_f32 v92, v76
    v_exp_f32 v93, v77
    v_exp_f32 v94, v78
    v_exp_f32 v95, v79
    v_mfma_f32_32x32x16_bf16 v[64:79], v[160:163], v[28:31], v[112:127]
    ds_read_b128 v[164:167], v185 offset:6336
    ds_read_b128 v[168:171], v186 offset:4224
    ds_read_b128 v[172:175], v186 offset:4768
    v_exp_f32 v48, v32
    v_exp_f32 v49, v33
    v_exp_f32 v50, v34
    v_exp_f32 v51, v35
    v_smfmac_f32_32x32x32_bf16 v[144:159], v[176:179], v[80:87], v184
    v_exp_f32 v52, v36
    v_exp_f32 v53, v37
    v_exp_f32 v54, v38
    v_exp_f32 v55, v39
    v_exp_f32 v56, v40
    v_exp_f32 v57, v41
    v_smfmac_f32_32x32x32_bf16 v[144:159], v[180:183], v[88:95], v184
    s_waitcnt lgkmcnt(0)
    v_exp_f32_e64 v58, v42
    v_exp_f32 v59, v43
    v_exp_f32 v60, v44
    v_exp_f32 v61, v45
    v_exp_f32 v62, v46
    v_exp_f32 v63, v47
    v_mfma_f32_32x32x16_bf16 v[32:47], v[164:167], v[24:27], v[96:111]
    v_exp_f32 v80, v64
    v_exp_f32 v81, v65
    v_exp_f32 v82, v66
    v_exp_f32 v83, v67
    v_smfmac_f32_32x32x32_bf16 v[128:143], v[168:171], v[48:55], v184
    v_exp_f32 v84, v68
    v_exp_f32 v85, v69
    v_exp_f32 v86, v70
    v_exp_f32 v87, v71
    v_exp_f32 v88, v72
    v_exp_f32 v89, v73
    v_smfmac_f32_32x32x32_bf16 v[128:143], v[172:175], v[56:63], v184
    v_exp_f32 v90, v74
    v_exp_f32 v91, v75
    v_exp_f32 v92, v76
    v_exp_f32 v93, v77
    v_exp_f32 v94, v78
    v_exp_f32 v95, v79
    v_mfma_f32_32x32x16_bf16 v[64:79], v[164:167], v[28:31], v[112:127]
    ds_read_b128 v[160:163], v185 offset:8448
    ds_read_b128 v[176:179], v186 offset:6336
    ds_read_b128 v[180:183], v186 offset:6880
    v_exp_f32 v48, v32
    v_exp_f32 v49, v33
    v_exp_f32 v50, v34
    v_exp_f32 v51, v35
    v_smfmac_f32_32x32x32_bf16 v[144:159], v[168:171], v[80:87], v184
    v_exp_f32 v52, v36
    v_exp_f32 v53, v37
    v_exp_f32 v54, v38
    v_exp_f32 v55, v39
    v_exp_f32 v56, v40
    v_exp_f32 v57, v41
    v_smfmac_f32_32x32x32_bf16 v[144:159], v[172:175], v[88:95], v184
    s_waitcnt lgkmcnt(0)
    v_exp_f32_e64 v58, v42
    v_exp_f32 v59, v43
    v_exp_f32 v60, v44
    v_exp_f32 v61, v45
    v_exp_f32 v62, v46
    v_exp_f32 v63, v47
    v_mfma_f32_32x32x16_bf16 v[32:47], v[160:163], v[24:27], v[96:111]
    v_exp_f32 v80, v64
    v_exp_f32 v81, v65
    v_exp_f32 v82, v66
    v_exp_f32 v83, v67
    v_smfmac_f32_32x32x32_bf16 v[128:143], v[176:179], v[48:55], v184
    s_waitcnt vmcnt(0)
    s_mov_b64 exec, 1
    ds_add_u32 v2, v3 offset:12
    s_mov_b64 exec, -1
    s_nop 0
    v_exp_f32 v84, v68
    v_exp_f32 v85, v69
    v_exp_f32 v86, v70
    v_exp_f32 v87, v71
    v_exp_f32 v88, v72
    v_exp_f32 v89, v73
    v_smfmac_f32_32x32x32_bf16 v[128:143], v[180:183], v[56:63], v184
    v_exp_f32 v90, v74
    v_exp_f32 v91, v75
    v_exp_f32 v92, v76
    v_exp_f32 v93, v77
    v_exp_f32 v94, v78
    v_exp_f32 v95, v79
    v_mfma_f32_32x32x16_bf16 v[64:79], v[160:163], v[28:31], v[112:127]
    ds_read_b128 v[164:167], v185 offset:10560
    ds_read_b128 v[168:171], v186 offset:8448
    ds_read_b128 v[172:175], v186 offset:8992
    v_exp_f32 v48, v32
    v_exp_f32 v49, v33
    v_exp_f32 v50, v34
    v_exp_f32 v51, v35
    v_smfmac_f32_32x32x32_bf16 v[144:159], v[176:179], v[80:87], v184
    v_exp_f32 v52, v36
    v_exp_f32 v53, v37
    v_exp_f32 v54, v38
    v_exp_f32 v55, v39
    v_exp_f32 v56, v40
    v_exp_f32 v57, v41
    v_smfmac_f32_32x32x32_bf16 v[144:159], v[180:183], v[88:95], v184
    s_waitcnt lgkmcnt(0)
    v_exp_f32_e64 v58, v42
    v_exp_f32 v59, v43
    v_exp_f32 v60, v44
    v_exp_f32 v61, v45
    v_exp_f32 v62, v46
    v_exp_f32 v63, v47
    v_mfma_f32_32x32x16_bf16 v[32:47], v[164:167], v[24:27], v[96:111]
    v_exp_f32 v80, v64
    v_exp_f32 v81, v65
    v_exp_f32 v82, v66
    v_exp_f32 v83, v67
    v_smfmac_f32_32x32x32_bf16 v[128:143], v[168:171], v[48:55], v184
    v_exp_f32 v84, v68
    v_exp_f32 v85, v69
    v_exp_f32 v86, v70
    v_exp_f32 v87, v71
    v_exp_f32 v88, v72
    v_exp_f32 v89, v73
    v_smfmac_f32_32x32x32_bf16 v[128:143], v[172:175], v[56:63], v184
    v_exp_f32 v90, v74
    v_exp_f32 v91, v75
    v_exp_f32 v92, v76
    v_exp_f32 v93, v77
    v_exp_f32 v94, v78
    v_exp_f32 v95, v79
    v_mfma_f32_32x32x16_bf16 v[64:79], v[164:167], v[28:31], v[112:127]
    ds_read_b128 v[160:163], v185 offset:12672
    ds_read_b128 v[176:179], v186 offset:10560
    ds_read_b128 v[180:183], v186 offset:11104
    v_exp_f32 v48, v32
    v_exp_f32 v49, v33
    v_exp_f32 v50, v34
    v_exp_f32 v51, v35
    v_smfmac_f32_32x32x32_bf16 v[144:159], v[168:171], v[80:87], v184
    v_exp_f32 v52, v36
    v_exp_f32 v53, v37
    v_exp_f32 v54, v38
    v_exp_f32 v55, v39
    v_exp_f32 v56, v40
    v_exp_f32 v57, v41
    v_smfmac_f32_32x32x32_bf16 v[144:159], v[172:175], v[88:95], v184
    s_waitcnt lgkmcnt(0)
    v_exp_f32_e64 v58, v42
    v_exp_f32 v59, v43
    v_exp_f32 v60, v44
    v_exp_f32 v61, v45
    v_exp_f32 v62, v46
    v_exp_f32 v63, v47
    v_mfma_f32_32x32x16_bf16 v[32:47], v[160:163], v[24:27], v[96:111]
    v_exp_f32 v80, v64
    v_exp_f32 v81, v65
    v_exp_f32 v82, v66
    v_exp_f32 v83, v67
    v_smfmac_f32_32x32x32_bf16 v[128:143], v[176:179], v[48:55], v184
    v_exp_f32 v84, v68
    v_exp_f32 v85, v69
    v_exp_f32 v86, v70
    v_exp_f32 v87, v71
    v_exp_f32 v88, v72
    v_exp_f32 v89, v73
    v_smfmac_f32_32x32x32_bf16 v[128:143], v[180:183], v[56:63], v184
    v_exp_f32 v90, v74
    v_exp_f32 v91, v75
    v_exp_f32 v92, v76
    v_exp_f32 v93, v77
    v_exp_f32 v94, v78
    v_exp_f32 v95, v79
    v_mfma_f32_32x32x16_bf16 v[64:79], v[160:163], v[28:31], v[112:127]
    ds_read_b128 v[164:167], v185 offset:14784
    ds_read_b128 v[168:171], v186 offset:12672
    ds_read_b128 v[172:175], v186 offset:13216
    ds_read_b32 v189, v2 offset:12
    v_exp_f32 v48, v32
    v_exp_f32 v49, v33
    v_exp_f32 v50, v34
    v_exp_f32 v51, v35
    v_smfmac_f32_32x32x32_bf16 v[144:159], v[176:179], v[80:87], v184
    v_exp_f32 v52, v36
    v_exp_f32 v53, v37
    v_exp_f32 v54, v38
    v_exp_f32 v55, v39
    v_exp_f32 v56, v40
    v_exp_f32 v57, v41
    v_smfmac_f32_32x32x32_bf16 v[144:159], v[180:183], v[88:95], v184
    s_waitcnt lgkmcnt(0)
    v_exp_f32_e64 v58, v42
    v_exp_f32 v59, v43
    v_exp_f32 v60, v44
    v_exp_f32 v61, v45
    v_exp_f32 v62, v46
    v_exp_f32 v63, v47
    v_mfma_f32_32x32x16_bf16 v[32:47], v[164:167], v[24:27], v[96:111]
    v_readfirstlane_b32 s45, v189
    v_exp_f32_e64 v80, v64
    v_exp_f32 v81, v65
    v_exp_f32 v82, v66
    v_exp_f32 v83, v67
    v_smfmac_f32_32x32x32_bf16 v[128:143], v[168:171], v[48:55], v184
    v_exp_f32 v84, v68
    v_exp_f32 v85, v69
    v_exp_f32 v86, v70
    v_exp_f32 v87, v71
    v_exp_f32 v88, v72
    v_exp_f32 v89, v73
    v_smfmac_f32_32x32x32_bf16 v[128:143], v[172:175], v[56:63], v184
    s_cmp_lt_u32 s45, 4
    s_cbranch_scc1 SB_60
SR_61:
    v_exp_f32 v90, v74
    v_exp_f32 v91, v75
    v_exp_f32 v92, v76
    v_exp_f32 v93, v77
    v_exp_f32 v94, v78
    v_exp_f32 v95, v79
    v_mfma_f32_32x32x16_bf16 v[64:79], v[164:167], v[28:31], v[112:127]
    ds_read_b128 v[160:163], v185 offset:16896
    ds_read_b128 v[176:179], v186 offset:14784
    ds_read_b128 v[180:183], v186 offset:15328
    v_exp_f32 v48, v32
    v_exp_f32 v49, v33
    v_exp_f32 v50, v34
    v_exp_f32 v51, v35
    v_smfmac_f32_32x32x32_bf16 v[144:159], v[168:171], v[80:87], v184
    v_exp_f32 v52, v36
    v_exp_f32 v53, v37
    v_exp_f32 v54, v38
    v_exp_f32 v55, v39
    v_exp_f32 v56, v40
    v_exp_f32 v57, v41
    v_smfmac_f32_32x32x32_bf16 v[144:159], v[172:175], v[88:95], v184
    s_waitcnt lgkmcnt(0)
    v_exp_f32_e64 v58, v42
    v_exp_f32 v59, v43
    v_exp_f32 v60, v44
    v_exp_f32 v61, v45
    v_exp_f32 v62, v46
    v_exp_f32 v63, v47
    v_mfma_f32_32x32x16_bf16 v[32:47], v[160:163], v[24:27], v[96:111]
    v_exp_f32 v80, v64
    v_exp_f32 v81, v65
    v_exp_f32 v82, v66
    v_exp_f32 v83, v67
    v_smfmac_f32_32x32x32_bf16 v[128:143], v[176:179], v[48:55], v184
    v_exp_f32 v84, v68
    v_exp_f32 v85, v69
    v_exp_f32 v86, v70
    v_exp_f32 v87, v71
    v_exp_f32 v88, v72
    v_exp_f32 v89, v73
    v_smfmac_f32_32x32x32_bf16 v[128:143], v[180:183], v[56:63], v184
    v_exp_f32 v90, v74
    v_exp_f32 v91, v75
    v_exp_f32 v92, v76
    v_exp_f32 v93, v77
    v_exp_f32 v94, v78
    v_exp_f32 v95, v79
    v_mfma_f32_32x32x16_bf16 v[64:79], v[160:163], v[28:31], v[112:127]
    ds_read_b128 v[164:167], v185 offset:19008
    ds_read_b128 v[168:171], v186 offset:16896
    ds_read_b128 v[172:175], v186 offset:17440
    v_exp_f32 v48, v32
    v_exp_f32 v49, v33
    v_exp_f32 v50, v34
    v_exp_f32 v51, v35
    v_smfmac_f32_32x32x32_bf16 v[144:159], v[176:179], v[80:87], v184
    v_exp_f32 v52, v36
    v_exp_f32 v53, v37
    v_exp_f32 v54, v38
    v_exp_f32 v55, v39
    v_exp_f32 v56, v40
    v_exp_f32 v57, v41
    v_smfmac_f32_32x32x32_bf16 v[144:159], v[180:183], v[88:95], v184
    s_waitcnt lgkmcnt(0)
    v_exp_f32_e64 v58, v42
    v_exp_f32 v59, v43
    v_exp_f32 v60, v44
    v_exp_f32 v61, v45
    v_exp_f32 v62, v46
    v_exp_f32 v63, v47
    v_mfma_f32_32x32x16_bf16 v[32:47], v[164:167], v[24:27], v[96:111]
    v_exp_f32 v80, v64
    v_exp_f32 v81, v65
    v_exp_f32 v82, v66
    v_exp_f32 v83, v67
    v_smfmac_f32_32x32x32_bf16 v[128:143], v[168:171], v[48:55], v184
    v_exp_f32 v84, v68
    v_exp_f32 v85, v69
    v_exp_f32 v86, v70
    v_exp_f32 v87, v71
    v_exp_f32 v88, v72
    v_exp_f32 v89, v73
    v_smfmac_f32_32x32x32_bf16 v[128:143], v[172:175], v[56:63], v184
    v_exp_f32 v90, v74
    v_exp_f32 v91, v75
    v_exp_f32 v92, v76
    v_exp_f32 v93, v77
    v_exp_f32 v94, v78
    v_exp_f32 v95, v79
    v_mfma_f32_32x32x16_bf16 v[64:79], v[164:167], v[28:31], v[112:127]
    ds_read_b128 v[160:163], v185 offset:21120
    ds_read_b128 v[176:179], v186 offset:19008
    ds_read_b128 v[180:183], v186 offset:19552
    v_exp_f32 v48, v32
    v_exp_f32 v49, v33
    v_exp_f32 v50, v34
    v_exp_f32 v51, v35
    v_smfmac_f32_32x32x32_bf16 v[144:159], v[168:171], v[80:87], v184
    v_exp_f32 v52, v36
    v_exp_f32 v53, v37
    v_exp_f32 v54, v38
    v_exp_f32 v55, v39
    v_exp_f32 v56, v40
    v_exp_f32 v57, v41
    v_smfmac_f32_32x32x32_bf16 v[144:159], v[172:175], v[88:95], v184
    s_waitcnt lgkmcnt(0)
    v_exp_f32_e64 v58, v42
    v_exp_f32 v59, v43
    v_exp_f32 v60, v44
    v_exp_f32 v61, v45
    v_exp_f32 v62, v46
    v_exp_f32 v63, v47
    v_mfma_f32_32x32x16_bf16 v[32:47], v[160:163], v[24:27], v[96:111]
    v_exp_f32 v80, v64
    v_exp_f32 v81, v65
    v_exp_f32 v82, v66
    v_exp_f32 v83, v67
    v_smfmac_f32_32x32x32_bf16 v[128:143], v[176:179], v[48:55], v184
    v_exp_f32 v84, v68
    v_exp_f32 v85, v69
    v_exp_f32 v86, v70
    v_exp_f32 v87, v71
    v_exp_f32 v88, v72
    v_exp_f32 v89, v73
    v_smfmac_f32_32x32x32_bf16 v[128:143], v[180:183], v[56:63], v184
    v_exp_f32 v90, v74
    v_exp_f32 v91, v75
    v_exp_f32 v92, v76
    v_exp_f32 v93, v77
    v_exp_f32 v94, v78
    v_exp_f32 v95, v79
    v_mfma_f32_32x32x16_bf16 v[64:79], v[160:163], v[28:31], v[112:127]
    ds_read_b128 v[164:167], v185 offset:23232
    ds_read_b128 v[168:171], v186 offset:21120
    ds_read_b128 v[172:175], v186 offset:21664
    v_exp_f32 v48, v32
    v_exp_f32 v49, v33
    v_exp_f32 v50, v34
    v_exp_f32 v51, v35
    v_smfmac_f32_32x32x32_bf16 v[144:159], v[176:179], v[80:87], v184
    v_exp_f32 v52, v36
    v_exp_f32 v53, v37
    v_exp_f32 v54, v38
    v_exp_f32 v55, v39
    v_exp_f32 v56, v40
    v_exp_f32 v57, v41
    v_smfmac_f32_32x32x32_bf16 v[144:159], v[180:183], v[88:95], v184
    s_waitcnt lgkmcnt(0)
    v_exp_f32_e64 v58, v42
    v_exp_f32 v59, v43
    v_exp_f32 v60, v44
    v_exp_f32 v61, v45
    v_exp_f32 v62, v46
    v_exp_f32 v63, v47
    v_mfma_f32_32x32x16_bf16 v[32:47], v[164:167], v[24:27], v[96:111]
    v_exp_f32 v80, v64
    v_exp_f32 v81, v65
    v_exp_f32 v82, v66
    v_exp_f32 v83, v67
    v_smfmac_f32_32x32x32_bf16 v[128:143], v[168:171], v[48:55], v184
    v_exp_f32 v84, v68
    v_exp_f32 v85, v69
    v_exp_f32 v86, v70
    v_exp_f32 v87, v71
    v_exp_f32 v88, v72
    v_exp_f32 v89, v73
    v_smfmac_f32_32x32x32_bf16 v[128:143], v[172:175], v[56:63], v184
    v_exp_f32 v90, v74
    v_exp_f32 v91, v75
    v_exp_f32 v92, v76
    v_exp_f32 v93, v77
    v_exp_f32 v94, v78
    v_exp_f32 v95, v79
    v_mfma_f32_32x32x16_bf16 v[64:79], v[164:167], v[28:31], v[112:127]
    ds_read_b128 v[160:163], v185 offset:25344
    ds_read_b128 v[176:179], v186 offset:23232
    ds_read_b128 v[180:183], v186 offset:23776
    v_exp_f32 v48, v32
    v_exp_f32 v49, v33
    v_exp_f32 v50, v34
    v_exp_f32 v51, v35
    v_smfmac_f32_32x32x32_bf16 v[144:159], v[168:171], v[80:87], v184
    v_exp_f32 v52, v36
    v_exp_f32 v53, v37
    v_exp_f32 v54, v38
    v_exp_f32 v55, v39
    v_exp_f32 v56, v40
    v_exp_f32 v57, v41
    v_smfmac_f32_32x32x32_bf16 v[144:159], v[172:175], v[88:95], v184
    s_waitcnt lgkmcnt(0)
    v_exp_f32_e64 v58, v42
    v_exp_f32 v59, v43
    v_exp_f32 v60, v44
    v_exp_f32 v61, v45
    v_exp_f32 v62, v46
    v_exp_f32 v63, v47
    v_mfma_f32_32x32x16_bf16 v[32:47], v[160:163], v[24:27], v[96:111]
    v_exp_f32 v80, v64
    v_exp_f32 v81, v65
    v_exp_f32 v82, v66
    v_exp_f32 v83, v67
    v_smfmac_f32_32x32x32_bf16 v[128:143], v[176:179], v[48:55], v184
    v_exp_f32 v84, v68
    v_exp_f32 v85, v69
    v_exp_f32 v86, v70
    v_exp_f32 v87, v71
    v_exp_f32 v88, v72
    v_exp_f32 v89, v73
    v_smfmac_f32_32x32x32_bf16 v[128:143], v[180:183], v[56:63], v184
    v_exp_f32 v90, v74
    v_exp_f32 v91, v75
    v_exp_f32 v92, v76
    v_exp_f32 v93, v77
    v_exp_f32 v94, v78
    v_exp_f32 v95, v79
    v_mfma_f32_32x32x16_bf16 v[64:79], v[160:163], v[28:31], v[112:127]
    ds_read_b128 v[164:167], v185 offset:27456
    ds_read_b128 v[168:171], v186 offset:25344
    ds_read_b128 v[172:175], v186 offset:25888
    v_exp_f32 v48, v32
    v_exp_f32 v49, v33
    v_exp_f32 v50, v34
    v_exp_f32 v51, v35
    v_smfmac_f32_32x32x32_bf16 v[144:159], v[176:179], v[80:87], v184
    v_exp_f32 v52, v36
    v_exp_f32 v53, v37
    v_exp_f32 v54, v38
    v_exp_f32 v55, v39
    v_exp_f32 v56, v40
    v_exp_f32 v57, v41
    v_smfmac_f32_32x32x32_bf16 v[144:159], v[180:183], v[88:95], v184
    s_waitcnt lgkmcnt(0)
    v_exp_f32_e64 v58, v42
    v_exp_f32 v59, v43
    v_exp_f32 v60, v44
    v_exp_f32 v61, v45
    v_exp_f32 v62, v46
    v_exp_f32 v63, v47
    v_mfma_f32_32x32x16_bf16 v[32:47], v[164:167], v[24:27], v[96:111]
    v_exp_f32 v80, v64
    v_exp_f32 v81, v65
    v_exp_f32 v82, v66
    v_exp_f32 v83, v67
    v_smfmac_f32_32x32x32_bf16 v[128:143], v[168:171], v[48:55], v184
    v_exp_f32 v84, v68
    v_exp_f32 v85, v69
    v_exp_f32 v86, v70
    v_exp_f32 v87, v71
    v_exp_f32 v88, v72
    v_exp_f32 v89, v73
    v_smfmac_f32_32x32x32_bf16 v[128:143], v[172:175], v[56:63], v184
    v_exp_f32 v90, v74
    v_exp_f32 v91, v75
    v_exp_f32 v92, v76
    v_exp_f32 v93, v77
    v_exp_f32 v94, v78
    v_exp_f32 v95, v79
    v_mfma_f32_32x32x16_bf16 v[64:79], v[164:167], v[28:31], v[112:127]
    ds_read_b128 v[160:163], v185 offset:29568
    ds_read_b128 v[176:179], v186 offset:27456
    ds_read_b128 v[180:183], v186 offset:28000
    v_exp_f32 v48, v32
    v_exp_f32 v49, v33
    v_exp_f32 v50, v34
    v_exp_f32 v51, v35
    v_smfmac_f32_32x32x32_bf16 v[144:159], v[168:171], v[80:87], v184
    v_exp_f32 v52, v36
    v_exp_f32 v53, v37
    v_exp_f32 v54, v38
    v_exp_f32 v55, v39
    v_exp_f32 v56, v40
    v_exp_f32 v57, v41
    v_smfmac_f32_32x32x32_bf16 v[144:159], v[172:175], v[88:95], v184
    s_waitcnt lgkmcnt(0)
    v_exp_f32_e64 v58, v42
    v_exp_f32 v59, v43
    v_exp_f32 v60, v44
    v_exp_f32 v61, v45
    v_exp_f32 v62, v46
    v_exp_f32 v63, v47
    v_mfma_f32_32x32x16_bf16 v[32:47], v[160:163], v[24:27], v[96:111]
    v_exp_f32 v80, v64
    v_exp_f32 v81, v65
    v_exp_f32 v82, v66
    v_exp_f32 v83, v67
    v_smfmac_f32_32x32x32_bf16 v[128:143], v[176:179], v[48:55], v184
    s_mov_b64 exec, 1
    s_nop 0
    ds_add_u32 v2, v3 offset:56
    s_mov_b64 exec, -1
    s_nop 0
    v_exp_f32 v84, v68
    v_exp_f32 v85, v69
    v_exp_f32 v86, v70
    v_exp_f32 v87, v71
    v_exp_f32 v88, v72
    v_exp_f32 v89, v73
    v_smfmac_f32_32x32x32_bf16 v[128:143], v[180:183], v[56:63], v184
    v_exp_f32 v90, v74
    v_exp_f32 v91, v75
    v_exp_f32 v92, v76
    v_exp_f32 v93, v77
    v_exp_f32 v94, v78
    v_exp_f32 v95, v79
    v_mfma_f32_32x32x16_bf16 v[64:79], v[160:163], v[28:31], v[112:127]
    ds_read_b128 v[164:167], v185 offset:31680
    ds_read_b128 v[168:171], v186 offset:29568
    ds_read_b128 v[172:175], v186 offset:30112
    ds_read_b32 v189, v188 offset:0
    v_exp_f32 v48, v32
    v_exp_f32 v49, v33
    v_exp_f32 v50, v34
    v_exp_f32 v51, v35
    v_smfmac_f32_32x32x32_bf16 v[144:159], v[176:179], v[80:87], v184
    v_exp_f32 v52, v36
    v_exp_f32 v53, v37
    v_exp_f32 v54, v38
    v_exp_f32 v55, v39
    v_exp_f32 v56, v40
    v_exp_f32 v57, v41
    v_smfmac_f32_32x32x32_bf16 v[144:159], v[180:183], v[88:95], v184
    s_waitcnt lgkmcnt(0)
    v_exp_f32_e64 v58, v42
    v_exp_f32 v59, v43
    v_exp_f32 v60, v44
    v_exp_f32 v61, v45
    v_exp_f32 v62, v46
    v_exp_f32 v63, v47
    v_mfma_f32_32x32x16_bf16 v[32:47], v[164:167], v[24:27], v[96:111]
    v_readfirstlane_b32 s45, v189
    v_exp_f32_e64 v80, v64
    v_exp_f32 v81, v65
    v_exp_f32 v82, v66
    v_exp_f32 v83, v67
    v_smfmac_f32_32x32x32_bf16 v[128:143], v[168:171], v[48:55], v184
    v_exp_f32 v84, v68
    v_exp_f32 v85, v69
    v_exp_f32 v86, v70
    v_exp_f32 v87, v71
    v_exp_f32 v88, v72
    v_exp_f32 v89, v73
    v_smfmac_f32_32x32x32_bf16 v[128:143], v[172:175], v[56:63], v184
    s_cmp_lt_u32 s45, 4
    s_cbranch_scc1 SB_64
SR_65:
    v_exp_f32 v90, v74
    v_exp_f32 v91, v75
    v_exp_f32 v92, v76
    v_exp_f32 v93, v77
    v_exp_f32 v94, v78
    v_exp_f32 v95, v79
    v_mfma_f32_32x32x16_bf16 v[64:79], v[164:167], v[28:31], v[112:127]
    ds_read_b128 v[160:163], v185 offset:33792
    ds_read_b128 v[176:179], v186 offset:31680
    ds_read_b128 v[180:183], v186 offset:32224
    v_exp_f32 v48, v32
    v_exp_f32 v49, v33
    v_exp_f32 v50, v34
    v_exp_f32 v51, v35
    v_smfmac_f32_32x32x32_bf16 v[144:159], v[168:171], v[80:87], v184
    v_exp_f32 v52, v36
    v_exp_f32 v53, v37
    v_exp_f32 v54, v38
    v_exp_f32 v55, v39
    v_exp_f32 v56, v40
    v_exp_f32 v57, v41
    v_smfmac_f32_32x32x32_bf16 v[144:159], v[172:175], v[88:95], v184
    s_waitcnt lgkmcnt(0)
    v_exp_f32_e64 v58, v42
    v_exp_f32 v59, v43
    v_exp_f32 v60, v44
    v_exp_f32 v61, v45
    v_exp_f32 v62, v46
    v_exp_f32 v63, v47
    v_mfma_f32_32x32x16_bf16 v[32:47], v[160:163], v[24:27], v[96:111]
    v_exp_f32 v80, v64
    v_exp_f32 v81, v65
    v_exp_f32 v82, v66
    v_exp_f32 v83, v67
    v_smfmac_f32_32x32x32_bf16 v[128:143], v[176:179], v[48:55], v184
    v_add_u32_e64 v188, s49, v188
    v_add_u32 v185, 33792, v185
    v_add_u32 v186, 33792, v186
    v_exp_f32 v84, v68
    v_exp_f32 v85, v69
    v_exp_f32 v86, v70
    v_exp_f32 v87, v71
    v_exp_f32 v88, v72
    v_exp_f32 v89, v73
    v_smfmac_f32_32x32x32_bf16 v[128:143], v[180:183], v[56:63], v184
    s_add_u32 s50, s50, 1
    s_bitcmp0_b32 s50, 2
    v_exp_f32 v90, v74
    v_exp_f32 v91, v75
    v_exp_f32 v92, v76
    v_exp_f32 v93, v77
    v_exp_f32 v94, v78
    v_exp_f32 v95, v79
    s_cbranch_scc1 L_ATT
    v_smfmac_f32_32x32x32_bf16 v[144:159], v[176:179], v[80:87], v184
    v_smfmac_f32_32x32x32_bf16 v[144:159], v[180:183], v[88:95], v184
    s_setprio 3
    s_mov_b64 exec, 1
    ds_add_u32 v187, v3 offset:60
    s_mov_b64 exec, -1
    s_setreg_imm32_b32 hwreg(HW_REG_MODE, 4, 2), 3
    v_mov_b32 v6, 0x76800000
    v_fma_f32 v4, v128, 0, v136
    v_fma_f32 v4, v129, 0, v4
    v_fma_f32 v4, v130, 0, v4
    v_fma_f32 v4, v131, 0, v4
    v_fma_f32 v4, v132, 0, v4
    v_fma_f32 v4, v133, 0, v4
    v_fma_f32 v4, v134, 0, v4
    v_fma_f32 v4, v135, 0, v4
    v_rcp_f32 v7, v136
    v_cmp_nlt_f32 s[54:55], v4, v6
    v_fma_f32 v4, v144, 0, v152
    v_fma_f32 v4, v145, 0, v4
    v_fma_f32 v4, v146, 0, v4
    v_fma_f32 v4, v147, 0, v4
    v_fma_f32 v4, v148, 0, v4
    v_fma_f32 v4, v149, 0, v4
    v_fma_f32 v4, v150, 0, v4
    v_fma_f32 v4, v151, 0, v4
    v_rcp_f32 v5, v152
    v_cmp_nlt_f32 vcc, v4, v6
    v_mul_f32 v128, v128, v7
    v_mul_f32 v129, v129, v7
    v_mul_f32 v130, v130, v7
    v_mul_f32 v131, v131, v7
    v_mul_f32 v132, v132, v7
    v_mul_f32 v133, v133, v7
    v_mul_f32 v134, v134, v7
    v_mul_f32 v135, v135, v7
    v_cvt_pk_bf16_f32 v32, v128, v129
    v_cvt_pk_bf16_f32 v33, v130, v131
    v_cvt_pk_bf16_f32 v34, v132, v133
    v_cvt_pk_bf16_f32 v35, v134, v135
    v_min_u32 v32, -2, v32
    v_min_u32 v33, -2, v33
    v_min_u32 v34, -2, v34
    v_min_u32 v35, -2, v35
    s_or_b64 vcc, vcc, s[54:55]
    s_cbranch_scc1 L_FALLBACK
L_ATT_OK:
    buffer_store_dwordx4 v[32:35], v8, s[12:15], s59 offen sc1
    v_mul_f32 v144, v144, v5
    v_mul_f32 v145, v145, v5
    v_mul_f32 v146, v146, v5
    v_mul_f32 v147, v147, v5
    v_mul_f32 v148, v148, v5
    v_mul_f32 v149, v149, v5
    v_mul_f32 v150, v150, v5
    v_mul_f32 v151, v151, v5
    v_cvt_pk_bf16_f32 v36, v144, v145
    v_cvt_pk_bf16_f32 v37, v146, v147
    v_cvt_pk_bf16_f32 v38, v148, v149
    v_cvt_pk_bf16_f32 v39, v150, v151
    v_min_u32 v36, -2, v36
    v_min_u32 v37, -2, v37
    v_min_u32 v38, -2, v38
    v_min_u32 v39, -2, v39
    buffer_store_dwordx4 v[36:39], v8, s[12:15], s59 offen offset:2048 sc1
    s_mov_b64 exec, 1
    ds_add_u32 v2, v3 offset:40
    s_mov_b64 exec, -1
    buffer_load_dwordx4 v[16:19], v13, s[4:7], 0 offen
    s_branch L_FINAL
L_G_EARLY:
    s_add_u32 m0, s46, 0
    s_nop 0
    buffer_load_dwordx4 v9, s[32:35], s48 offen lds
    buffer_load_dwordx4 v10, s[32:35], s48 offen offset:1024 lds
    s_add_u32 s48, s48, s49
    s_add_u32 m0, s46, 2048
    s_nop 0
    buffer_load_dwordx4 v9, s[32:35], s48 offen lds
    buffer_load_dwordx4 v10, s[32:35], s48 offen offset:1024 lds
    s_add_u32 s48, s48, s49
    s_add_u32 m0, s46, 4096
    s_nop 0
    buffer_load_dwordx4 v9, s[32:35], s48 offen lds
    buffer_load_dwordx4 v10, s[32:35], s48 offen offset:1024 lds
    s_add_u32 s48, s48, s49
    s_waitcnt vmcnt(13)
    v_lshlrev_b32 v64, 16, v32
    v_and_b32 v65, 0xffff0000, v32
    v_lshlrev_b32 v66, 16, v33
    v_and_b32 v67, 0xffff0000, v33
    v_lshlrev_b32 v68, 16, v34
    v_and_b32 v69, 0xffff0000, v34
    v_lshlrev_b32 v70, 16, v35
    v_and_b32 v71, 0xffff0000, v35
    v_pk_mul_f32 v[132:133], v[64:65], v[64:65]
    v_mov_b64 v[128:129], v[64:65]
    v_pk_mul_f32 v[134:135], v[66:67], v[66:67]
    v_mov_b64 v[130:131], v[66:67]
    v_pk_add_f32 v[128:129], v[128:129], v[68:69]
    v_pk_fma_f32 v[132:133], v[68:69], v[68:69], v[132:133]
    v_pk_add_f32 v[130:131], v[130:131], v[70:71]
    v_pk_fma_f32 v[134:135], v[70:71], v[70:71], v[134:135]
    s_waitcnt vmcnt(12)
    v_lshlrev_b32 v72, 16, v36
    v_and_b32 v73, 0xffff0000, v36
    v_lshlrev_b32 v74, 16, v37
    v_and_b32 v75, 0xffff0000, v37
    v_lshlrev_b32 v76, 16, v38
    v_and_b32 v77, 0xffff0000, v38
    v_lshlrev_b32 v78, 16, v39
    v_and_b32 v79, 0xffff0000, v39
    v_pk_add_f32 v[128:129], v[128:129], v[72:73]
    v_pk_fma_f32 v[132:133], v[72:73], v[72:73], v[132:133]
    v_pk_add_f32 v[130:131], v[130:131], v[74:75]
    v_pk_fma_f32 v[134:135], v[74:75], v[74:75], v[134:135]
    v_pk_add_f32 v[128:129], v[128:129], v[76:77]
    v_pk_fma_f32 v[132:133], v[76:77], v[76:77], v[132:133]
    v_pk_add_f32 v[130:131], v[130:131], v[78:79]
    v_pk_fma_f32 v[134:135], v[78:79], v[78:79], v[134:135]
    s_waitcnt vmcnt(11)
    v_lshlrev_b32 v80, 16, v40
    v_and_b32 v81, 0xffff0000, v40
    v_lshlrev_b32 v82, 16, v41
    v_and_b32 v83, 0xffff0000, v41
    v_lshlrev_b32 v84, 16, v42
    v_and_b32 v85, 0xffff0000, v42
    v_lshlrev_b32 v86, 16, v43
    v_and_b32 v87, 0xffff0000, v43
    v_pk_add_f32 v[128:129], v[128:129], v[80:81]
    v_pk_fma_f32 v[132:133], v[80:81], v[80:81], v[132:133]
    v_pk_add_f32 v[130:131], v[130:131], v[82:83]
    v_pk_fma_f32 v[134:135], v[82:83], v[82:83], v[134:135]
    v_pk_add_f32 v[128:129], v[128:129], v[84:85]
    v_pk_fma_f32 v[132:133], v[84:85], v[84:85], v[132:133]
    v_pk_add_f32 v[130:131], v[130:131], v[86:87]
    v_pk_fma_f32 v[134:135], v[86:87], v[86:87], v[134:135]
    s_waitcnt vmcnt(10)
    v_lshlrev_b32 v88, 16, v44
    v_and_b32 v89, 0xffff0000, v44
    v_lshlrev_b32 v90, 16, v45
    v_and_b32 v91, 0xffff0000, v45
    v_lshlrev_b32 v92, 16, v46
    v_and_b32 v93, 0xffff0000, v46
    v_lshlrev_b32 v94, 16, v47
    v_and_b32 v95, 0xffff0000, v47
    v_pk_add_f32 v[128:129], v[128:129], v[88:89]
    v_pk_fma_f32 v[132:133], v[88:89], v[88:89], v[132:133]
    v_pk_add_f32 v[130:131], v[130:131], v[90:91]
    v_pk_fma_f32 v[134:135], v[90:91], v[90:91], v[134:135]
    v_pk_add_f32 v[128:129], v[128:129], v[92:93]
    v_pk_fma_f32 v[132:133], v[92:93], v[92:93], v[132:133]
    v_pk_add_f32 v[130:131], v[130:131], v[94:95]
    v_pk_fma_f32 v[134:135], v[94:95], v[94:95], v[134:135]
    s_waitcnt vmcnt(9)
    v_lshlrev_b32 v96, 16, v48
    v_and_b32 v97, 0xffff0000, v48
    v_lshlrev_b32 v98, 16, v49
    v_and_b32 v99, 0xffff0000, v49
    v_lshlrev_b32 v100, 16, v50
    v_and_b32 v101, 0xffff0000, v50
    v_lshlrev_b32 v102, 16, v51
    v_and_b32 v103, 0xffff0000, v51
    v_pk_add_f32 v[128:129], v[128:129], v[96:97]
    v_pk_fma_f32 v[132:133], v[96:97], v[96:97], v[132:133]
    v_pk_add_f32 v[130:131], v[130:131], v[98:99]
    v_pk_fma_f32 v[134:135], v[98:99], v[98:99], v[134:135]
    v_pk_add_f32 v[128:129], v[128:129], v[100:101]
    v_pk_fma_f32 v[132:133], v[100:101], v[100:101], v[132:133]
    v_pk_add_f32 v[130:131], v[130:131], v[102:103]
    v_pk_fma_f32 v[134:135], v[102:103], v[102:103], v[134:135]
    s_waitcnt vmcnt(8)
    v_lshlrev_b32 v104, 16, v52
    v_and_b32 v105, 0xffff0000, v52
    v_lshlrev_b32 v106, 16, v53
    v_and_b32 v107, 0xffff0000, v53
    v_lshlrev_b32 v108, 16, v54
    v_and_b32 v109, 0xffff0000, v54
    v_lshlrev_b32 v110, 16, v55
    v_and_b32 v111, 0xffff0000, v55
    v_pk_add_f32 v[128:129], v[128:129], v[104:105]
    v_pk_fma_f32 v[132:133], v[104:105], v[104:105], v[132:133]
    v_pk_add_f32 v[130:131], v[130:131], v[106:107]
    v_pk_fma_f32 v[134:135], v[106:107], v[106:107], v[134:135]
    v_pk_add_f32 v[128:129], v[128:129], v[108:109]
    v_pk_fma_f32 v[132:133], v[108:109], v[108:109], v[132:133]
    v_pk_add_f32 v[130:131], v[130:131], v[110:111]
    v_pk_fma_f32 v[134:135], v[110:111], v[110:111], v[134:135]
    s_waitcnt vmcnt(7)
    v_lshlrev_b32 v112, 16, v56
    v_and_b32 v113, 0xffff0000, v56
    v_lshlrev_b32 v114, 16, v57
    v_and_b32 v115, 0xffff0000, v57
    v_lshlrev_b32 v116, 16, v58
    v_and_b32 v117, 0xffff0000, v58
    v_lshlrev_b32 v118, 16, v59
    v_and_b32 v119, 0xffff0000, v59
    v_pk_add_f32 v[128:129], v[128:129], v[112:113]
    v_pk_fma_f32 v[132:133], v[112:113], v[112:113], v[132:133]
    v_pk_add_f32 v[130:131], v[130:131], v[114:115]
    v_pk_fma_f32 v[134:135], v[114:115], v[114:115], v[134:135]
    v_pk_add_f32 v[128:129], v[128:129], v[116:117]
    v_pk_fma_f32 v[132:133], v[116:117], v[116:117], v[132:133]
    v_pk_add_f32 v[130:131], v[130:131], v[118:119]
    v_pk_fma_f32 v[134:135], v[118:119], v[118:119], v[134:135]
    s_waitcnt vmcnt(6)
    v_lshlrev_b32 v120, 16, v60
    v_and_b32 v121, 0xffff0000, v60
    v_lshlrev_b32 v122, 16, v61
    v_and_b32 v123, 0xffff0000, v61
    v_lshlrev_b32 v124, 16, v62
    v_and_b32 v125, 0xffff0000, v62
    v_lshlrev_b32 v126, 16, v63
    v_and_b32 v127, 0xffff0000, v63
    v_pk_add_f32 v[128:129], v[128:129], v[120:121]
    v_pk_fma_f32 v[132:133], v[120:121], v[120:121], v[132:133]
    v_pk_add_f32 v[130:131], v[130:131], v[122:123]
    v_pk_fma_f32 v[134:135], v[122:123], v[122:123], v[134:135]
    v_pk_add_f32 v[128:129], v[128:129], v[124:125]
    v_pk_fma_f32 v[132:133], v[124:125], v[124:125], v[132:133]
    v_pk_add_f32 v[130:131], v[130:131], v[126:127]
    v_pk_fma_f32 v[134:135], v[126:127], v[126:127], v[134:135]
    s_branch L_LN2
L_OR0:
    s_sub_u32 s47, s47, 1
    s_cselect_b32 s47, 0, s47
    s_cbranch_scc1 L_OM0
    s_waitcnt vmcnt(0)
    buffer_load_dwordx4 v[32:35], v8, s[12:15], s60 offen offset:0 sc1
    buffer_load_dwordx4 v[36:39], v8, s[12:15], s60 offen offset:1024 sc1
    buffer_load_dwordx4 v[40:43], v8, s[12:15], s60 offen offset:2048 sc1
    buffer_load_dwordx4 v[44:47], v8, s[12:15], s60 offen offset:3072 sc1
    buffer_load_dwordx4 v[48:51], v8, s[12:15], s61 offen offset:0 sc1
    buffer_load_dwordx4 v[52:55], v8, s[12:15], s61 offen offset:1024 sc1
    buffer_load_dwordx4 v[56:59], v8, s[12:15], s61 offen offset:2048 sc1
    buffer_load_dwordx4 v[60:63], v8, s[12:15], s61 offen offset:3072 sc1
    buffer_load_dwordx4 v[64:67], v8, s[12:15], s62 offen offset:0 sc1
    buffer_load_dwordx4 v[68:71], v8, s[12:15], s62 offen offset:1024 sc1
    buffer_load_dwordx4 v[72:75], v8, s[12:15], s62 offen offset:2048 sc1
    buffer_load_dwordx4 v[76:79], v8, s[12:15], s62 offen offset:3072 sc1
    buffer_load_dwordx4 v[80:83], v8, s[12:15], s63 offen offset:0 sc1
    buffer_load_dwordx4 v[84:87], v8, s[12:15], s63 offen offset:1024 sc1
    buffer_load_dwordx4 v[88:91], v8, s[12:15], s63 offen offset:2048 sc1
    buffer_load_dwordx4 v[92:95], v8, s[12:15], s63 offen offset:3072 sc1
    s_branch L_OW0
L_OR1:
    s_sub_u32 s47, s47, 1
    s_cselect_b32 s47, 0, s47
    s_cbranch_scc1 L_OM1
    s_waitcnt vmcnt(0)
    buffer_load_dwordx4 v[48:51], v8, s[12:15], s61 offen offset:0 sc1
    buffer_load_dwordx4 v[52:55], v8, s[12:15], s61 offen offset:1024 sc1
    buffer_load_dwordx4 v[56:59], v8, s[12:15], s61 offen offset:2048 sc1
    buffer_load_dwordx4 v[60:63], v8, s[12:15], s61 offen offset:3072 sc1
    buffer_load_dwordx4 v[64:67], v8, s[12:15], s62 offen offset:0 sc1
    buffer_load_dwordx4 v[68:71], v8, s[12:15], s62 offen offset:1024 sc1
    buffer_load_dwordx4 v[72:75], v8, s[12:15], s62 offen offset:2048 sc1
    buffer_load_dwordx4 v[76:79], v8, s[12:15], s62 offen offset:3072 sc1
    buffer_load_dwordx4 v[80:83], v8, s[12:15], s63 offen offset:0 sc1
    buffer_load_dwordx4 v[84:87], v8, s[12:15], s63 offen offset:1024 sc1
    buffer_load_dwordx4 v[88:91], v8, s[12:15], s63 offen offset:2048 sc1
    buffer_load_dwordx4 v[92:95], v8, s[12:15], s63 offen offset:3072 sc1
    s_branch L_OW1
L_OR2:
    s_sub_u32 s47, s47, 1
    s_cselect_b32 s47, 0, s47
    s_cbranch_scc1 L_OM2
    s_waitcnt vmcnt(0)
    buffer_load_dwordx4 v[64:67], v8, s[12:15], s62 offen offset:0 sc1
    buffer_load_dwordx4 v[68:71], v8, s[12:15], s62 offen offset:1024 sc1
    buffer_load_dwordx4 v[72:75], v8, s[12:15], s62 offen offset:2048 sc1
    buffer_load_dwordx4 v[76:79], v8, s[12:15], s62 offen offset:3072 sc1
    buffer_load_dwordx4 v[80:83], v8, s[12:15], s63 offen offset:0 sc1
    buffer_load_dwordx4 v[84:87], v8, s[12:15], s63 offen offset:1024 sc1
    buffer_load_dwordx4 v[88:91], v8, s[12:15], s63 offen offset:2048 sc1
    buffer_load_dwordx4 v[92:95], v8, s[12:15], s63 offen offset:3072 sc1
    s_branch L_OW2
L_OR3:
    s_sub_u32 s47, s47, 1
    s_cselect_b32 s47, 0, s47
    s_cbranch_scc1 L_OM3
    s_waitcnt vmcnt(0)
    buffer_load_dwordx4 v[80:83], v8, s[12:15], s63 offen offset:0 sc1
    buffer_load_dwordx4 v[84:87], v8, s[12:15], s63 offen offset:1024 sc1
    buffer_load_dwordx4 v[88:91], v8, s[12:15], s63 offen offset:2048 sc1
    buffer_load_dwordx4 v[92:95], v8, s[12:15], s63 offen offset:3072 sc1
    s_branch L_OW3
SB_60:
    s_mov_b32 s47, 32768
WC_62:
    ds_read_b32 v4, v2 offset:12
    s_waitcnt lgkmcnt(0)
    v_readfirstlane_b32 s43, v4
    s_sub_u32 s47, s47, 1
    s_cbranch_scc1 WD_63
    s_cmp_ge_u32 s43, 4
    s_cbranch_scc1 WD_63
    s_branch WC_62
WD_63:
    s_branch SR_61
SB_64:
    s_mov_b32 s47, 32768
WC_66:
    ds_read_b32 v4, v188 offset:0
    s_waitcnt lgkmcnt(0)
    v_readfirstlane_b32 s43, v4
    s_sub_u32 s47, s47, 1
    s_cbranch_scc1 WD_67
    s_cmp_ge_u32 s43, 4
    s_cbranch_scc1 WD_67
    s_branch WC_66
WD_67:
    s_branch SR_65
L_FALLBACK:
    s_cmp_lg_u32 s53, 0
    s_cbranch_scc1 L_ATT_OK
    s_mov_b32 s53, 16
    v_mov_b32 v188, v2
    s_mov_b32 s49, 0
    v_subrev_u32 v185, 135168, v185
    v_subrev_u32 v186, 135168, v186
    v_mov_b32 v7, v185
    v_mov_b32 v4, 0xff800000
    v_mov_b32 v5, 0xff800000
    s_mov_b32 s50, 0
L_MAXP:
    ds_read_b128 v[160:163], v7
    v_add_u32 v7, 2112, v7
    s_waitcnt lgkmcnt(0)
    v_mfma_f32_32x32x16_bf16 v[32:47], v[160:163], v[24:27], 0
    v_mfma_f32_32x32x16_bf16 v[64:79], v[160:163], v[28:31], 0
    s_nop 11
    v_max3_f32 v4, v4, v32, v33
    v_max3_f32 v4, v4, v34, v35
    v_max3_f32 v4, v4, v36, v37
    v_max3_f32 v4, v4, v38, v39
    v_max3_f32 v4, v4, v40, v41
    v_max3_f32 v4, v4, v42, v43
    v_max3_f32 v4, v4, v44, v45
    v_max3_f32 v4, v4, v46, v47
    v_max3_f32 v5, v5, v64, v65
    v_max3_f32 v5, v5, v66, v67
    v_max3_f32 v5, v5, v68, v69
    v_max3_f32 v5, v5, v70, v71
    v_max3_f32 v5, v5, v72, v73
    v_max3_f32 v5, v5, v74, v75
    v_max3_f32 v5, v5, v76, v77
    v_max3_f32 v5, v5, v78, v79
    s_add_u32 s50, s50, 1
    s_cmp_lt_u32 s50, 64
    s_cbranch_scc1 L_MAXP
    ds_read_b128 v[160:163], v185
    v_mov_b32 v6, v4
    s_nop 1
    v_permlane32_swap_b32 v4, v6
    s_nop 1
    v_max_f32 v4, v4, v6
    v_mov_b32 v6, v5
    s_nop 1
    v_permlane32_swap_b32 v5, v6
    s_nop 1
    v_max_f32 v5, v5, v6
    v_mov_b64 v[128:129], 0
    v_mov_b64 v[144:145], 0
    v_mov_b64 v[80:81], 0
    v_mov_b64 v[130:131], 0
    v_mov_b64 v[146:147], 0
    v_mov_b64 v[82:83], 0
    v_mov_b64 v[132:133], 0
    v_mov_b64 v[148:149], 0
    v_mov_b64 v[84:85], 0
    v_mov_b64 v[134:135], 0
    v_mov_b64 v[150:151], 0
    v_mov_b64 v[86:87], 0
    v_mov_b64 v[136:137], 0
    v_mov_b64 v[152:153], 0
    v_mov_b64 v[88:89], 0
    v_mov_b64 v[138:139], 0
    v_mov_b64 v[154:155], 0
    v_mov_b64 v[90:91], 0
    v_mov_b64 v[140:141], 0
    v_mov_b64 v[156:157], 0
    v_mov_b64 v[92:93], 0
    v_mov_b64 v[142:143], 0
    v_mov_b64 v[158:159], 0
    v_mov_b64 v[94:95], 0
    v_mov_b64 v[176:177], 0
    v_mov_b64 v[178:179], 0
    v_mov_b64 v[180:181], 0
    v_mov_b64 v[182:183], 0
    s_waitcnt lgkmcnt(0)
    s_branch L_ATT_START
L_CODE_END:
.section .rodata,"a"
.p2align 6
.amdhsa_kernel parallel_sum__grouped_kv_mqa__dense_activation_relu__prompt_kernel
  .amdhsa_next_free_vgpr 256
  .amdhsa_next_free_sgpr 102
  .amdhsa_accum_offset 256
  .amdhsa_group_segment_fixed_size 0
  .amdhsa_kernarg_size 88
  .amdhsa_user_sgpr_count 2
  .amdhsa_user_sgpr_kernarg_segment_ptr 1
  .amdhsa_system_sgpr_workgroup_id_x 1
.end_amdhsa_kernel
```
